```python
import torch

def _softmax(x, axis=-1):
    return torch.softmax(x, dim=axis)

def _gelu(x):
    return torch.nn.functional.gelu(x, approximate='tanh')

def _silu(x):
    return torch.nn.functional.silu(x)

def _sigmoid(x):
    return torch.sigmoid(x)

def _layernorm(x, axis=-1, eps=1e-05):
    m = x.mean(dim=axis, keepdim=True)
    v = x.var(dim=axis, keepdim=True, unbiased=False)
    return (x - m) / torch.sqrt(v + eps)

def _scatter_add(tgt, idx, src, axis=0):
    return tgt.clone().index_add_(axis, idx, src)

def _segment_sum(src, seg, n):
    out = torch.zeros((n,) + src.shape[1:], dtype=src.dtype)
    return out.index_add_(0, seg, src)

def _pad(x, pw):
    flat = tuple((v for pair in reversed(pw) for v in pair))
    return torch.nn.functional.pad(x, flat)
kernel_name = 'adaLN_cond__grouped_kv_mqa__glu_gated_reglu__prompt'

def setup_inputs():

    _w = lambda a: (lambda t: t.to(torch.bfloat16) if t.is_floating_point() else t)(torch.as_tensor(a))

    def _A_setup():
        B, S, D, H = (1, 2048, 512, 32)
        Dh = D // H
        return {'x': _w((lambda *s: torch.randn(*s, dtype=torch.bfloat16) * 0.05)(B, S, D)), 'wq': _w((lambda *s: torch.randn(*s, dtype=torch.bfloat16) * 0.1)(D, H * Dh)), 'wk': _w((lambda *s: torch.randn(*s, dtype=torch.bfloat16) * 0.1)(D, Dh)), 'wv': _w((lambda *s: torch.randn(*s, dtype=torch.bfloat16) * 0.1)(D, Dh)), 'wo': _w((lambda *s: torch.randn(*s, dtype=torch.bfloat16) * 0.1)(H * Dh, D))}
    _A_in = _A_setup()

    def _B_setup():
        B, S, D, F = (1, 2048, 512, 1792)
        return {'x': _w((lambda *s: torch.randn(*s, dtype=torch.bfloat16) * 0.05)(B, S, D)), 'W_gate': _w((lambda *s: torch.randn(*s, dtype=torch.bfloat16) * 1.6)(D, F) * (2.0 / D) ** 0.5), 'W_up': _w((lambda *s: torch.randn(*s, dtype=torch.bfloat16) * 1.6)(D, F) * (2.0 / D) ** 0.5), 'W_down': _w((lambda *s: torch.randn(*s, dtype=torch.bfloat16) * 1.6)(F, D) * (1.0 / F) ** 0.5)}
    _B_in = _B_setup()
    return {'A_x': _A_in['x'], 'A_wq': _A_in['wq'], 'A_wk': _A_in['wk'], 'A_wv': _A_in['wv'], 'A_wo': _A_in['wo'], 'B_x': _B_in['x'], 'B_W_gate': _B_in['W_gate'], 'B_W_up': _B_in['W_up'], 'B_W_down': _B_in['W_down'], 'c': _w((lambda *s: torch.randn(*s, dtype=torch.bfloat16) * 0.2)(1, 512) * 8.0), 'w_mod': _w((lambda *s: torch.randn(*s, dtype=torch.bfloat16) * 0.2)(512, 6 * 512) * 512 ** (-0.5) * 8.0)}

def reference(A_x, A_wq, A_wk, A_wv, A_wo, B_x, B_W_gate, B_W_up, B_W_down, c, w_mod):

    def _A_ref(x, wq, wk, wv, wo):
        B, S, D = x.shape
        H = 32
        Dh = D // H
        q = (lambda x, *d: x.permute(*d))((x @ wq).reshape(B, S, H, Dh), 0, 2, 1, 3)
        k = x @ wk
        v = x @ wv
        scores = torch.einsum('bhqd,bkd->bhqk', q, k) * Dh ** (-0.5)
        p = _softmax(scores, axis=-1)
        o = torch.einsum('bhqk,bkd->bhqd', p, v)
        return (lambda x, *d: x.permute(*d))(o, 0, 2, 1, 3).reshape(B, S, H * Dh) @ wo

    def _B_ref(x, W_gate, W_up, W_down):
        gate = torch.einsum('bsd,df->bsf', x, W_gate)
        up = torch.einsum('bsd,df->bsf', x, W_up)
        gate = gate * (lambda x, dt: x.to(dt))(gate > 0, gate.dtype)
        h = gate * up
        return torch.einsum('bsf,fd->bsd', h, W_down)
    x = A_x
    mod = (_silu(c) @ w_mod).reshape(c.shape[0], 6, 1, -1)
    sa, ca, ga, sb, cb, gb = (mod[:, 0].clone(), mod[:, 1].clone(), mod[:, 2].clone(), mod[:, 3].clone(), mod[:, 4].clone(), mod[:, 5].clone())
    h = _layernorm(x, axis=-1) * (1 + ca) + sa
    x = x + ga * _A_ref(h, A_wq, A_wk, A_wv, A_wo)
    h = _layernorm(x, axis=-1) * (1 + cb) + sb
    x = x + gb * _B_ref(h, B_W_gate, B_W_up, B_W_down)
    return x
```

```asm
; @launch kernel=k0_kernel grid=(232,1,1) block=(256,1,1) lds=10240
; @launch kernel=k1_kernel grid=(256,1,1) block=(256,1,1) lds=51200
; @launch kernel=k2_kernel grid=(256,1,1) block=(512,1,1) lds=160256
; @launch kernel=k4_kernel grid=(256,1,1) block=(256,1,1) lds=163840
; @launch kernel=k5_kernel grid=(256,1,1) block=(256,1,1) lds=81920
.amdgcn_target "amdgcn-amd-amdhsa--gfx950"
.text
.globl k0_kernel
.p2align 8
.type k0_kernel,@function
k0_kernel:
    s_cmp_ge_u32 s2, 232
    s_cbranch_scc1 k0_kernel_end
    s_load_dwordx16 s[16:31], s[0:1], 0
    s_load_dwordx8 s[32:39], s[0:1], 64
    s_load_dwordx4 s[40:43], s[0:1], 96
    v_lshrrev_b32 v1, 6, v0
    v_and_b32 v2, 63, v0
    s_nop 0
    v_readfirstlane_b32 s3, v1
    s_waitcnt lgkmcnt(0)
    s_mov_b32 s8, s42
    s_and_b32 s9, s43, 0xffff
    s_mov_b32 s10, 33554432
    s_mov_b32 s11, 0x00020000
    s_cmp_ge_u32 s2, 96
    s_cbranch_scc1 k0_kernel_pack
    s_mov_b32 s4, s36
    s_and_b32 s5, s37, 0xffff
    s_mov_b32 s6, 3145728
    s_mov_b32 s7, 0x00020000
    s_mov_b32 s12, s34
    s_and_b32 s13, s35, 0xffff
    s_mov_b32 s14, 1024
    s_mov_b32 s15, 0x00020000
    v_and_b32 v3, 3, v0
    v_lshrrev_b32 v4, 2, v0
    v_lshlrev_b32 v6, 4, v4
    buffer_load_dwordx4 v[8:11], v6, s[12:15], 0 offen
    s_mov_b32 s47, 49152
    v_mul_lo_u32 v7, v4, s47
    s_lshl_b32 s48, s2, 6
    v_lshl_add_u32 v5, v3, 4, s48
    v_add_u32 v7, v7, v5
    s_mov_b32 s50, 0
    s_mov_b32 s51, 6144
    s_mov_b32 s52, 12288
    s_mov_b32 s53, 18432
    s_mov_b32 s54, 24576
    s_mov_b32 s55, 30720
    s_mov_b32 s56, 36864
    s_mov_b32 s57, 43008
    buffer_load_dwordx4 v[16:19], v7, s[4:7], s50 offen
    buffer_load_dwordx4 v[20:23], v7, s[4:7], s51 offen
    buffer_load_dwordx4 v[24:27], v7, s[4:7], s52 offen
    buffer_load_dwordx4 v[28:31], v7, s[4:7], s53 offen
    buffer_load_dwordx4 v[32:35], v7, s[4:7], s54 offen
    buffer_load_dwordx4 v[36:39], v7, s[4:7], s55 offen
    buffer_load_dwordx4 v[40:43], v7, s[4:7], s56 offen
    buffer_load_dwordx4 v[44:47], v7, s[4:7], s57 offen
    s_waitcnt vmcnt(8)
    v_lshlrev_b32 v48, 16, v8
    v_and_b32 v49, 0xffff0000, v8
    v_lshlrev_b32 v50, 16, v9
    v_and_b32 v51, 0xffff0000, v9
    v_lshlrev_b32 v52, 16, v10
    v_and_b32 v53, 0xffff0000, v10
    v_lshlrev_b32 v54, 16, v11
    v_and_b32 v55, 0xffff0000, v11
    s_mov_b32 s60, 0xbfb8aa3b
    v_mul_f32 v56, s60, v48
    v_mul_f32 v57, s60, v49
    v_mul_f32 v58, s60, v50
    v_mul_f32 v59, s60, v51
    v_mul_f32 v60, s60, v52
    v_mul_f32 v61, s60, v53
    v_mul_f32 v62, s60, v54
    v_mul_f32 v63, s60, v55
    v_exp_f32 v56, v56
    v_exp_f32 v57, v57
    v_exp_f32 v58, v58
    v_exp_f32 v59, v59
    v_exp_f32 v60, v60
    v_exp_f32 v61, v61
    v_exp_f32 v62, v62
    v_exp_f32 v63, v63
    s_nop 0
    v_add_f32 v56, 1.0, v56
    v_add_f32 v57, 1.0, v57
    v_add_f32 v58, 1.0, v58
    v_add_f32 v59, 1.0, v59
    v_add_f32 v60, 1.0, v60
    v_add_f32 v61, 1.0, v61
    v_add_f32 v62, 1.0, v62
    v_add_f32 v63, 1.0, v63
    v_rcp_f32 v56, v56
    v_rcp_f32 v57, v57
    v_rcp_f32 v58, v58
    v_rcp_f32 v59, v59
    v_rcp_f32 v60, v60
    v_rcp_f32 v61, v61
    v_rcp_f32 v62, v62
    v_rcp_f32 v63, v63
    s_nop 0
    v_mul_f32 v48, v48, v56
    v_mul_f32 v49, v49, v57
    v_mul_f32 v50, v50, v58
    v_mul_f32 v51, v51, v59
    v_mul_f32 v52, v52, v60
    v_mul_f32 v53, v53, v61
    v_mul_f32 v54, v54, v62
    v_mul_f32 v55, v55, v63
    v_cvt_pk_bf16_f32 v56, v48, v49
    v_cvt_pk_bf16_f32 v57, v50, v51
    v_cvt_pk_bf16_f32 v58, v52, v53
    v_cvt_pk_bf16_f32 v59, v54, v55
    v_lshlrev_b32 v48, 16, v56
    v_and_b32 v49, 0xffff0000, v56
    v_lshlrev_b32 v50, 16, v57
    v_and_b32 v51, 0xffff0000, v57
    v_lshlrev_b32 v52, 16, v58
    v_and_b32 v53, 0xffff0000, v58
    v_lshlrev_b32 v54, 16, v59
    v_and_b32 v55, 0xffff0000, v59
    s_waitcnt vmcnt(0)
    v_lshlrev_b32 v56, 16, v16
    v_and_b32 v57, 0xffff0000, v16
    v_mul_f32 v64, v48, v56
    v_mul_f32 v65, v48, v57
    v_lshlrev_b32 v56, 16, v17
    v_and_b32 v57, 0xffff0000, v17
    v_mul_f32 v66, v48, v56
    v_mul_f32 v67, v48, v57
    v_lshlrev_b32 v56, 16, v18
    v_and_b32 v57, 0xffff0000, v18
    v_mul_f32 v68, v48, v56
    v_mul_f32 v69, v48, v57
    v_lshlrev_b32 v56, 16, v19
    v_and_b32 v57, 0xffff0000, v19
    v_mul_f32 v70, v48, v56
    v_mul_f32 v71, v48, v57
    v_lshlrev_b32 v56, 16, v20
    v_and_b32 v57, 0xffff0000, v20
    v_fmac_f32 v64, v49, v56
    v_fmac_f32 v65, v49, v57
    v_lshlrev_b32 v56, 16, v21
    v_and_b32 v57, 0xffff0000, v21
    v_fmac_f32 v66, v49, v56
    v_fmac_f32 v67, v49, v57
    v_lshlrev_b32 v56, 16, v22
    v_and_b32 v57, 0xffff0000, v22
    v_fmac_f32 v68, v49, v56
    v_fmac_f32 v69, v49, v57
    v_lshlrev_b32 v56, 16, v23
    v_and_b32 v57, 0xffff0000, v23
    v_fmac_f32 v70, v49, v56
    v_fmac_f32 v71, v49, v57
    v_lshlrev_b32 v56, 16, v24
    v_and_b32 v57, 0xffff0000, v24
    v_fmac_f32 v64, v50, v56
    v_fmac_f32 v65, v50, v57
    v_lshlrev_b32 v56, 16, v25
    v_and_b32 v57, 0xffff0000, v25
    v_fmac_f32 v66, v50, v56
    v_fmac_f32 v67, v50, v57
    v_lshlrev_b32 v56, 16, v26
    v_and_b32 v57, 0xffff0000, v26
    v_fmac_f32 v68, v50, v56
    v_fmac_f32 v69, v50, v57
    v_lshlrev_b32 v56, 16, v27
    v_and_b32 v57, 0xffff0000, v27
    v_fmac_f32 v70, v50, v56
    v_fmac_f32 v71, v50, v57
    v_lshlrev_b32 v56, 16, v28
    v_and_b32 v57, 0xffff0000, v28
    v_fmac_f32 v64, v51, v56
    v_fmac_f32 v65, v51, v57
    v_lshlrev_b32 v56, 16, v29
    v_and_b32 v57, 0xffff0000, v29
    v_fmac_f32 v66, v51, v56
    v_fmac_f32 v67, v51, v57
    v_lshlrev_b32 v56, 16, v30
    v_and_b32 v57, 0xffff0000, v30
    v_fmac_f32 v68, v51, v56
    v_fmac_f32 v69, v51, v57
    v_lshlrev_b32 v56, 16, v31
    v_and_b32 v57, 0xffff0000, v31
    v_fmac_f32 v70, v51, v56
    v_fmac_f32 v71, v51, v57
    v_lshlrev_b32 v56, 16, v32
    v_and_b32 v57, 0xffff0000, v32
    v_fmac_f32 v64, v52, v56
    v_fmac_f32 v65, v52, v57
    v_lshlrev_b32 v56, 16, v33
    v_and_b32 v57, 0xffff0000, v33
    v_fmac_f32 v66, v52, v56
    v_fmac_f32 v67, v52, v57
    v_lshlrev_b32 v56, 16, v34
    v_and_b32 v57, 0xffff0000, v34
    v_fmac_f32 v68, v52, v56
    v_fmac_f32 v69, v52, v57
    v_lshlrev_b32 v56, 16, v35
    v_and_b32 v57, 0xffff0000, v35
    v_fmac_f32 v70, v52, v56
    v_fmac_f32 v71, v52, v57
    v_lshlrev_b32 v56, 16, v36
    v_and_b32 v57, 0xffff0000, v36
    v_fmac_f32 v64, v53, v56
    v_fmac_f32 v65, v53, v57
    v_lshlrev_b32 v56, 16, v37
    v_and_b32 v57, 0xffff0000, v37
    v_fmac_f32 v66, v53, v56
    v_fmac_f32 v67, v53, v57
    v_lshlrev_b32 v56, 16, v38
    v_and_b32 v57, 0xffff0000, v38
    v_fmac_f32 v68, v53, v56
    v_fmac_f32 v69, v53, v57
    v_lshlrev_b32 v56, 16, v39
    v_and_b32 v57, 0xffff0000, v39
    v_fmac_f32 v70, v53, v56
    v_fmac_f32 v71, v53, v57
    v_lshlrev_b32 v56, 16, v40
    v_and_b32 v57, 0xffff0000, v40
    v_fmac_f32 v64, v54, v56
    v_fmac_f32 v65, v54, v57
    v_lshlrev_b32 v56, 16, v41
    v_and_b32 v57, 0xffff0000, v41
    v_fmac_f32 v66, v54, v56
    v_fmac_f32 v67, v54, v57
    v_lshlrev_b32 v56, 16, v42
    v_and_b32 v57, 0xffff0000, v42
    v_fmac_f32 v68, v54, v56
    v_fmac_f32 v69, v54, v57
    v_lshlrev_b32 v56, 16, v43
    v_and_b32 v57, 0xffff0000, v43
    v_fmac_f32 v70, v54, v56
    v_fmac_f32 v71, v54, v57
    v_lshlrev_b32 v56, 16, v44
    v_and_b32 v57, 0xffff0000, v44
    v_fmac_f32 v64, v55, v56
    v_fmac_f32 v65, v55, v57
    v_lshlrev_b32 v56, 16, v45
    v_and_b32 v57, 0xffff0000, v45
    v_fmac_f32 v66, v55, v56
    v_fmac_f32 v67, v55, v57
    v_lshlrev_b32 v56, 16, v46
    v_and_b32 v57, 0xffff0000, v46
    v_fmac_f32 v68, v55, v56
    v_fmac_f32 v69, v55, v57
    v_lshlrev_b32 v56, 16, v47
    v_and_b32 v57, 0xffff0000, v47
    v_fmac_f32 v70, v55, v56
    v_fmac_f32 v71, v55, v57
    v_mul_u32_u24 v58, 144, v4
    v_lshl_add_u32 v58, v3, 5, v58
    ds_write_b128 v58, v[64:67]
    ds_write_b128 v58, v[68:71] offset:16
    s_waitcnt lgkmcnt(0)
    s_barrier
    v_and_b32 v59, 31, v0
    v_lshrrev_b32 v60, 5, v0
    v_mul_u32_u24 v61, 1152, v60
    v_lshl_add_u32 v61, v59, 2, v61
    ds_read_b32 v64, v61 offset:0
    ds_read_b32 v65, v61 offset:144
    ds_read_b32 v66, v61 offset:288
    ds_read_b32 v67, v61 offset:432
    ds_read_b32 v68, v61 offset:576
    ds_read_b32 v69, v61 offset:720
    ds_read_b32 v70, v61 offset:864
    ds_read_b32 v71, v61 offset:1008
    s_waitcnt lgkmcnt(0)
    v_add_f32 v64, v64, v65
    v_add_f32 v64, v64, v66
    v_add_f32 v64, v64, v67
    v_add_f32 v64, v64, v68
    v_add_f32 v64, v64, v69
    v_add_f32 v64, v64, v70
    v_add_f32 v64, v64, v71
    v_lshlrev_b32 v62, 2, v0
    ds_write_b32 v62, v64 offset:9216
    s_waitcnt lgkmcnt(0)
    s_barrier
    v_cmp_gt_u32 vcc, 32, v0
    s_and_saveexec_b64 s[54:55], vcc
    s_cbranch_execz k0_kernel_end
    ds_read_b32 v64, v62 offset:9216
    ds_read_b32 v65, v62 offset:9344
    ds_read_b32 v66, v62 offset:9472
    ds_read_b32 v67, v62 offset:9600
    ds_read_b32 v68, v62 offset:9728
    ds_read_b32 v69, v62 offset:9856
    ds_read_b32 v70, v62 offset:9984
    ds_read_b32 v71, v62 offset:10112
    s_waitcnt lgkmcnt(0)
    v_add_f32 v64, v64, v65
    v_add_f32 v64, v64, v66
    v_add_f32 v64, v64, v67
    v_add_f32 v64, v64, v68
    v_add_f32 v64, v64, v69
    v_add_f32 v64, v64, v70
    v_add_f32 v64, v64, v71
    v_cvt_pk_bf16_f32 v64, v64, v64
    v_lshlrev_b32 v64, 16, v64
    s_lshl_b32 s56, s2, 7
    s_add_u32 s56, s56, 131072
    buffer_store_dword v64, v62, s[8:11], s56 offen
    s_endpgm
k0_kernel_pack:
    s_cmp_ge_u32 s2, 128
    s_cbranch_scc1 k0_kernel_p_after_wq
    s_sub_u32 s44, s2, 96
    s_lshl_b32 s44, s44, 2
    s_add_u32 s44, s44, s3
    s_lshr_b32 s45, s44, 6
    s_and_b32 s46, s44, 63
    s_lshl_b32 s45, s45, 8
    v_lshl_add_u32 v10, v2, 2, s45
    v_mov_b32 v11, s46
    s_mov_b32 s4, s18
    s_and_b32 s5, s19, 0xffff
    s_mov_b32 s6, 524288
    s_mov_b32 s7, 0x00020000
    s_mov_b32 s60, 8192
    v_mul_lo_u32 v12, v11, s60
    v_lshl_add_u32 v12, v10, 1, v12
    s_mov_b32 s61, 0
    s_mov_b32 s62, 1024
    s_mov_b32 s63, 2048
    s_mov_b32 s64, 3072
    s_mov_b32 s65, 4096
    s_mov_b32 s66, 5120
    s_mov_b32 s67, 6144
    s_mov_b32 s68, 7168
    buffer_load_dwordx2 v[16:17], v12, s[4:7], s61 offen
    buffer_load_dwordx2 v[18:19], v12, s[4:7], s62 offen
    buffer_load_dwordx2 v[20:21], v12, s[4:7], s63 offen
    buffer_load_dwordx2 v[22:23], v12, s[4:7], s64 offen
    buffer_load_dwordx2 v[24:25], v12, s[4:7], s65 offen
    buffer_load_dwordx2 v[26:27], v12, s[4:7], s66 offen
    buffer_load_dwordx2 v[28:29], v12, s[4:7], s67 offen
    buffer_load_dwordx2 v[30:31], v12, s[4:7], s68 offen
    v_lshrrev_b32 v13, 5, v10
    s_mov_b32 s60, 32768
    v_mul_lo_u32 v13, v13, s60
    v_lshrrev_b32 v14, 1, v11
    v_lshl_add_u32 v13, v14, 10, v13
    v_and_b32 v14, 1, v11
    v_mul_u32_u24 v14, 32, v14
    v_and_b32 v15, 31, v10
    v_add_u32 v14, v14, v15
    v_add_u32 v14, 0, v14
    v_lshl_add_u32 v13, v14, 4, v13
    v_add_u32 v13, 1048576, v13
    s_mov_b32 s70, 0x05040100
    s_mov_b32 s71, 0x07060302
    s_waitcnt vmcnt(0)
    v_perm_b32 v32, v18, v16, s70
    v_perm_b32 v33, v22, v20, s70
    v_perm_b32 v34, v26, v24, s70
    v_perm_b32 v35, v30, v28, s70
    v_perm_b32 v36, v18, v16, s71
    v_perm_b32 v37, v22, v20, s71
    v_perm_b32 v38, v26, v24, s71
    v_perm_b32 v39, v30, v28, s71
    v_perm_b32 v40, v19, v17, s70
    v_perm_b32 v41, v23, v21, s70
    v_perm_b32 v42, v27, v25, s70
    v_perm_b32 v43, v31, v29, s70
    v_perm_b32 v44, v19, v17, s71
    v_perm_b32 v45, v23, v21, s71
    v_perm_b32 v46, v27, v25, s71
    v_perm_b32 v47, v31, v29, s71
    buffer_store_dwordx4 v[32:35], v13, s[8:11], 0 offen offset:0
    buffer_store_dwordx4 v[36:39], v13, s[8:11], 0 offen offset:16
    buffer_store_dwordx4 v[40:43], v13, s[8:11], 0 offen offset:32
    buffer_store_dwordx4 v[44:47], v13, s[8:11], 0 offen offset:48
    s_endpgm
k0_kernel_p_after_wq:
    s_cmp_ge_u32 s2, 160
    s_cbranch_scc1 k0_kernel_p_after_wo
    s_sub_u32 s44, s2, 128
    s_lshl_b32 s44, s44, 2
    s_add_u32 s44, s44, s3
    s_lshr_b32 s45, s44, 6
    s_and_b32 s46, s44, 63
    s_lshl_b32 s45, s45, 8
    v_lshl_add_u32 v10, v2, 2, s45
    v_mov_b32 v11, s46
    s_mov_b32 s4, s24
    s_and_b32 s5, s25, 0xffff
    s_mov_b32 s6, 524288
    s_mov_b32 s7, 0x00020000
    s_mov_b32 s60, 8192
    v_mul_lo_u32 v12, v11, s60
    v_lshl_add_u32 v12, v10, 1, v12
    s_mov_b32 s61, 0
    s_mov_b32 s62, 1024
    s_mov_b32 s63, 2048
    s_mov_b32 s64, 3072
    s_mov_b32 s65, 4096
    s_mov_b32 s66, 5120
    s_mov_b32 s67, 6144
    s_mov_b32 s68, 7168
    buffer_load_dwordx2 v[16:17], v12, s[4:7], s61 offen
    buffer_load_dwordx2 v[18:19], v12, s[4:7], s62 offen
    buffer_load_dwordx2 v[20:21], v12, s[4:7], s63 offen
    buffer_load_dwordx2 v[22:23], v12, s[4:7], s64 offen
    buffer_load_dwordx2 v[24:25], v12, s[4:7], s65 offen
    buffer_load_dwordx2 v[26:27], v12, s[4:7], s66 offen
    buffer_load_dwordx2 v[28:29], v12, s[4:7], s67 offen
    buffer_load_dwordx2 v[30:31], v12, s[4:7], s68 offen
    v_lshrrev_b32 v13, 4, v10
    s_mov_b32 s60, 16384
    v_mul_lo_u32 v13, v13, s60
    v_lshrrev_b32 v14, 2, v11
    v_lshl_add_u32 v13, v14, 10, v13
    v_and_b32 v14, 3, v11
    v_mul_u32_u24 v14, 16, v14
    v_and_b32 v15, 15, v10
    v_add_u32 v14, v14, v15
    v_add_u32 v14, 0, v14
    v_lshl_add_u32 v13, v14, 4, v13
    v_add_u32 v13, 2097152, v13
    s_mov_b32 s70, 0x05040100
    s_mov_b32 s71, 0x07060302
    s_waitcnt vmcnt(0)
    v_perm_b32 v32, v18, v16, s70
    v_perm_b32 v33, v22, v20, s70
    v_perm_b32 v34, v26, v24, s70
    v_perm_b32 v35, v30, v28, s70
    v_perm_b32 v36, v18, v16, s71
    v_perm_b32 v37, v22, v20, s71
    v_perm_b32 v38, v26, v24, s71
    v_perm_b32 v39, v30, v28, s71
    v_perm_b32 v40, v19, v17, s70
    v_perm_b32 v41, v23, v21, s70
    v_perm_b32 v42, v27, v25, s70
    v_perm_b32 v43, v31, v29, s70
    v_perm_b32 v44, v19, v17, s71
    v_perm_b32 v45, v23, v21, s71
    v_perm_b32 v46, v27, v25, s71
    v_perm_b32 v47, v31, v29, s71
    buffer_store_dwordx4 v[32:35], v13, s[8:11], 0 offen offset:0
    buffer_store_dwordx4 v[36:39], v13, s[8:11], 0 offen offset:16
    buffer_store_dwordx4 v[40:43], v13, s[8:11], 0 offen offset:32
    buffer_store_dwordx4 v[44:47], v13, s[8:11], 0 offen offset:48
    s_endpgm
k0_kernel_p_after_wo:
    s_cmp_ge_u32 s2, 168
    s_cbranch_scc1 k0_kernel_p_after_kv
    s_sub_u32 s44, s2, 160
    s_lshl_b32 s44, s44, 2
    s_add_u32 s44, s44, s3
    s_cmp_ge_u32 s44, 8
    s_cbranch_scc1 k0_kernel_end
    s_and_b32 s46, s44, 3
    s_lshl_b32 s46, s46, 4
    v_and_b32 v10, 3, v2
    v_lshlrev_b32 v10, 2, v10
    v_lshrrev_b32 v11, 2, v2
    v_add_u32 v11, s46, v11
    s_cmp_ge_u32 s44, 4
    s_cbranch_scc1 k0_kernel_p_wv
    s_mov_b32 s4, s20
    s_and_b32 s5, s21, 0xffff
    s_mov_b32 s6, 16384
    s_mov_b32 s7, 0x00020000
    s_mov_b32 s60, 256
    v_mul_lo_u32 v12, v11, s60
    v_lshl_add_u32 v12, v10, 1, v12
    s_mov_b32 s61, 0
    s_mov_b32 s62, 32
    s_mov_b32 s63, 64
    s_mov_b32 s64, 96
    s_mov_b32 s65, 128
    s_mov_b32 s66, 160
    s_mov_b32 s67, 192
    s_mov_b32 s68, 224
    buffer_load_dwordx2 v[16:17], v12, s[4:7], s61 offen
    buffer_load_dwordx2 v[18:19], v12, s[4:7], s62 offen
    buffer_load_dwordx2 v[20:21], v12, s[4:7], s63 offen
    buffer_load_dwordx2 v[22:23], v12, s[4:7], s64 offen
    buffer_load_dwordx2 v[24:25], v12, s[4:7], s65 offen
    buffer_load_dwordx2 v[26:27], v12, s[4:7], s66 offen
    buffer_load_dwordx2 v[28:29], v12, s[4:7], s67 offen
    buffer_load_dwordx2 v[30:31], v12, s[4:7], s68 offen
    v_lshrrev_b32 v13, 4, v10
    s_mov_b32 s60, 32768
    v_mul_lo_u32 v13, v13, s60
    v_lshrrev_b32 v14, 1, v11
    v_lshl_add_u32 v13, v14, 10, v13
    v_and_b32 v14, 1, v11
    v_mul_u32_u24 v14, 32, v14
    v_and_b32 v15, 15, v10
    v_add_u32 v14, v14, v15
    v_add_u32 v14, 0, v14
    v_lshl_add_u32 v13, v14, 4, v13
    v_add_u32 v13, 1572864, v13
    s_mov_b32 s70, 0x05040100
    s_mov_b32 s71, 0x07060302
    s_waitcnt vmcnt(0)
    v_perm_b32 v32, v18, v16, s70
    v_perm_b32 v33, v22, v20, s70
    v_perm_b32 v34, v26, v24, s70
    v_perm_b32 v35, v30, v28, s70
    v_perm_b32 v36, v18, v16, s71
    v_perm_b32 v37, v22, v20, s71
    v_perm_b32 v38, v26, v24, s71
    v_perm_b32 v39, v30, v28, s71
    v_perm_b32 v40, v19, v17, s70
    v_perm_b32 v41, v23, v21, s70
    v_perm_b32 v42, v27, v25, s70
    v_perm_b32 v43, v31, v29, s70
    v_perm_b32 v44, v19, v17, s71
    v_perm_b32 v45, v23, v21, s71
    v_perm_b32 v46, v27, v25, s71
    v_perm_b32 v47, v31, v29, s71
    buffer_store_dwordx4 v[32:35], v13, s[8:11], 0 offen offset:0
    buffer_store_dwordx4 v[36:39], v13, s[8:11], 0 offen offset:16
    buffer_store_dwordx4 v[40:43], v13, s[8:11], 0 offen offset:32
    buffer_store_dwordx4 v[44:47], v13, s[8:11], 0 offen offset:48
    s_endpgm
k0_kernel_p_wv:
    s_mov_b32 s4, s22
    s_and_b32 s5, s23, 0xffff
    s_mov_b32 s6, 16384
    s_mov_b32 s7, 0x00020000
    s_mov_b32 s60, 256
    v_mul_lo_u32 v12, v11, s60
    v_lshl_add_u32 v12, v10, 1, v12
    s_mov_b32 s61, 0
    s_mov_b32 s62, 32
    s_mov_b32 s63, 64
    s_mov_b32 s64, 96
    s_mov_b32 s65, 128
    s_mov_b32 s66, 160
    s_mov_b32 s67, 192
    s_mov_b32 s68, 224
    buffer_load_dwordx2 v[16:17], v12, s[4:7], s61 offen
    buffer_load_dwordx2 v[18:19], v12, s[4:7], s62 offen
    buffer_load_dwordx2 v[20:21], v12, s[4:7], s63 offen
    buffer_load_dwordx2 v[22:23], v12, s[4:7], s64 offen
    buffer_load_dwordx2 v[24:25], v12, s[4:7], s65 offen
    buffer_load_dwordx2 v[26:27], v12, s[4:7], s66 offen
    buffer_load_dwordx2 v[28:29], v12, s[4:7], s67 offen
    buffer_load_dwordx2 v[30:31], v12, s[4:7], s68 offen
    v_lshrrev_b32 v13, 4, v10
    s_mov_b32 s60, 32768
    v_mul_lo_u32 v13, v13, s60
    v_lshrrev_b32 v14, 1, v11
    v_lshl_add_u32 v13, v14, 10, v13
    v_and_b32 v14, 1, v11
    v_mul_u32_u24 v14, 32, v14
    v_and_b32 v15, 15, v10
    v_add_u32 v14, v14, v15
    v_add_u32 v14, 16, v14
    v_lshl_add_u32 v13, v14, 4, v13
    v_add_u32 v13, 1572864, v13
    s_mov_b32 s70, 0x05040100
    s_mov_b32 s71, 0x07060302
    s_waitcnt vmcnt(0)
    v_perm_b32 v32, v18, v16, s70
    v_perm_b32 v33, v22, v20, s70
    v_perm_b32 v34, v26, v24, s70
    v_perm_b32 v35, v30, v28, s70
    v_perm_b32 v36, v18, v16, s71
    v_perm_b32 v37, v22, v20, s71
    v_perm_b32 v38, v26, v24, s71
    v_perm_b32 v39, v30, v28, s71
    v_perm_b32 v40, v19, v17, s70
    v_perm_b32 v41, v23, v21, s70
    v_perm_b32 v42, v27, v25, s70
    v_perm_b32 v43, v31, v29, s70
    v_perm_b32 v44, v19, v17, s71
    v_perm_b32 v45, v23, v21, s71
    v_perm_b32 v46, v27, v25, s71
    v_perm_b32 v47, v31, v29, s71
    buffer_store_dwordx4 v[32:35], v13, s[8:11], 0 offen offset:0
    buffer_store_dwordx4 v[36:39], v13, s[8:11], 0 offen offset:16
    buffer_store_dwordx4 v[40:43], v13, s[8:11], 0 offen offset:32
    buffer_store_dwordx4 v[44:47], v13, s[8:11], 0 offen offset:48
    s_endpgm
k0_kernel_p_after_kv:
    s_cmp_ge_u32 s2, 232
    s_cbranch_scc1 k0_kernel_p_after_xp
    s_sub_u32 s44, s2, 168
    s_lshl_b32 s44, s44, 2
    s_add_u32 s44, s44, s3
    s_mov_b32 s4, s16
    s_and_b32 s5, s17, 0xffff
    s_mov_b32 s6, 2097152
    s_mov_b32 s7, 0x00020000
    s_and_b32 s45, s2, 7
    s_sub_u32 s46, s2, 168
    s_lshr_b32 s46, s46, 3
    s_lshl_b32 s45, s45, 18
    s_lshl_b32 s46, s46, 15
    s_add_u32 s45, s45, s46
    s_lshl_b32 s46, s3, 13
    s_add_u32 s45, s45, s46
    v_lshlrev_b32 v3, 4, v2
    s_add_u32 s47, s45, 4096
    buffer_load_dwordx4 v[16:19], v3, s[4:7], s45 offen offset:0
    buffer_load_dwordx4 v[20:23], v3, s[4:7], s45 offen offset:1024
    buffer_load_dwordx4 v[24:27], v3, s[4:7], s45 offen offset:2048
    buffer_load_dwordx4 v[28:31], v3, s[4:7], s45 offen offset:3072
    buffer_load_dwordx4 v[32:35], v3, s[4:7], s47 offen offset:0
    buffer_load_dwordx4 v[36:39], v3, s[4:7], s47 offen offset:1024
    buffer_load_dwordx4 v[40:43], v3, s[4:7], s47 offen offset:2048
    buffer_load_dwordx4 v[44:47], v3, s[4:7], s47 offen offset:3072
    s_waitcnt vmcnt(0)
    v_lshlrev_b32 v48, 16, v16
    v_and_b32 v49, 0xffff0000, v16
    v_lshlrev_b32 v50, 16, v17
    v_and_b32 v51, 0xffff0000, v17
    v_lshlrev_b32 v52, 16, v18
    v_and_b32 v53, 0xffff0000, v18
    v_lshlrev_b32 v54, 16, v19
    v_and_b32 v55, 0xffff0000, v19
    v_lshlrev_b32 v56, 16, v20
    v_and_b32 v57, 0xffff0000, v20
    v_lshlrev_b32 v58, 16, v21
    v_and_b32 v59, 0xffff0000, v21
    v_lshlrev_b32 v60, 16, v22
    v_and_b32 v61, 0xffff0000, v22
    v_lshlrev_b32 v62, 16, v23
    v_and_b32 v63, 0xffff0000, v23
    v_lshlrev_b32 v64, 16, v24
    v_and_b32 v65, 0xffff0000, v24
    v_lshlrev_b32 v66, 16, v25
    v_and_b32 v67, 0xffff0000, v25
    v_lshlrev_b32 v68, 16, v26
    v_and_b32 v69, 0xffff0000, v26
    v_lshlrev_b32 v70, 16, v27
    v_and_b32 v71, 0xffff0000, v27
    v_lshlrev_b32 v72, 16, v28
    v_and_b32 v73, 0xffff0000, v28
    v_lshlrev_b32 v74, 16, v29
    v_and_b32 v75, 0xffff0000, v29
    v_lshlrev_b32 v76, 16, v30
    v_and_b32 v77, 0xffff0000, v30
    v_lshlrev_b32 v78, 16, v31
    v_and_b32 v79, 0xffff0000, v31
    v_lshlrev_b32 v80, 16, v32
    v_and_b32 v81, 0xffff0000, v32
    v_lshlrev_b32 v82, 16, v33
    v_and_b32 v83, 0xffff0000, v33
    v_lshlrev_b32 v84, 16, v34
    v_and_b32 v85, 0xffff0000, v34
    v_lshlrev_b32 v86, 16, v35
    v_and_b32 v87, 0xffff0000, v35
    v_lshlrev_b32 v88, 16, v36
    v_and_b32 v89, 0xffff0000, v36
    v_lshlrev_b32 v90, 16, v37
    v_and_b32 v91, 0xffff0000, v37
    v_lshlrev_b32 v92, 16, v38
    v_and_b32 v93, 0xffff0000, v38
    v_lshlrev_b32 v94, 16, v39
    v_and_b32 v95, 0xffff0000, v39
    v_lshlrev_b32 v96, 16, v40
    v_and_b32 v97, 0xffff0000, v40
    v_lshlrev_b32 v98, 16, v41
    v_and_b32 v99, 0xffff0000, v41
    v_lshlrev_b32 v100, 16, v42
    v_and_b32 v101, 0xffff0000, v42
    v_lshlrev_b32 v102, 16, v43
    v_and_b32 v103, 0xffff0000, v43
    v_lshlrev_b32 v104, 16, v44
    v_and_b32 v105, 0xffff0000, v44
    v_lshlrev_b32 v106, 16, v45
    v_and_b32 v107, 0xffff0000, v45
    v_lshlrev_b32 v108, 16, v46
    v_and_b32 v109, 0xffff0000, v46
    v_lshlrev_b32 v110, 16, v47
    v_and_b32 v111, 0xffff0000, v47
    v_add_f32 v8, v48, v49
    v_add_f32 v9, v56, v57
    v_add_f32 v10, v64, v65
    v_add_f32 v11, v72, v73
    v_add_f32 v12, v80, v81
    v_add_f32 v13, v88, v89
    v_add_f32 v14, v96, v97
    v_add_f32 v15, v104, v105
    v_add_f32 v8, v8, v50
    v_add_f32 v9, v9, v58
    v_add_f32 v10, v10, v66
    v_add_f32 v11, v11, v74
    v_add_f32 v12, v12, v82
    v_add_f32 v13, v13, v90
    v_add_f32 v14, v14, v98
    v_add_f32 v15, v15, v106
    v_add_f32 v8, v8, v51
    v_add_f32 v9, v9, v59
    v_add_f32 v10, v10, v67
    v_add_f32 v11, v11, v75
    v_add_f32 v12, v12, v83
    v_add_f32 v13, v13, v91
    v_add_f32 v14, v14, v99
    v_add_f32 v15, v15, v107
    v_add_f32 v8, v8, v52
    v_add_f32 v9, v9, v60
    v_add_f32 v10, v10, v68
    v_add_f32 v11, v11, v76
    v_add_f32 v12, v12, v84
    v_add_f32 v13, v13, v92
    v_add_f32 v14, v14, v100
    v_add_f32 v15, v15, v108
    v_add_f32 v8, v8, v53
    v_add_f32 v9, v9, v61
    v_add_f32 v10, v10, v69
    v_add_f32 v11, v11, v77
    v_add_f32 v12, v12, v85
    v_add_f32 v13, v13, v93
    v_add_f32 v14, v14, v101
    v_add_f32 v15, v15, v109
    v_add_f32 v8, v8, v54
    v_add_f32 v9, v9, v62
    v_add_f32 v10, v10, v70
    v_add_f32 v11, v11, v78
    v_add_f32 v12, v12, v86
    v_add_f32 v13, v13, v94
    v_add_f32 v14, v14, v102
    v_add_f32 v15, v15, v110
    v_add_f32 v8, v8, v55
    v_add_f32 v9, v9, v63
    v_add_f32 v10, v10, v71
    v_add_f32 v11, v11, v79
    v_add_f32 v12, v12, v87
    v_add_f32 v13, v13, v95
    v_add_f32 v14, v14, v103
    v_add_f32 v15, v15, v111
    v_add_f32_dpp v8, v8, v8 quad_perm:[1,0,3,2] row_mask:0xf bank_mask:0xf
    v_add_f32_dpp v9, v9, v9 quad_perm:[1,0,3,2] row_mask:0xf bank_mask:0xf
    v_add_f32_dpp v10, v10, v10 quad_perm:[1,0,3,2] row_mask:0xf bank_mask:0xf
    v_add_f32_dpp v11, v11, v11 quad_perm:[1,0,3,2] row_mask:0xf bank_mask:0xf
    v_add_f32_dpp v12, v12, v12 quad_perm:[1,0,3,2] row_mask:0xf bank_mask:0xf
    v_add_f32_dpp v13, v13, v13 quad_perm:[1,0,3,2] row_mask:0xf bank_mask:0xf
    v_add_f32_dpp v14, v14, v14 quad_perm:[1,0,3,2] row_mask:0xf bank_mask:0xf
    v_add_f32_dpp v15, v15, v15 quad_perm:[1,0,3,2] row_mask:0xf bank_mask:0xf
    v_add_f32_dpp v8, v8, v8 quad_perm:[2,3,0,1] row_mask:0xf bank_mask:0xf
    v_add_f32_dpp v9, v9, v9 quad_perm:[2,3,0,1] row_mask:0xf bank_mask:0xf
    v_add_f32_dpp v10, v10, v10 quad_perm:[2,3,0,1] row_mask:0xf bank_mask:0xf
    v_add_f32_dpp v11, v11, v11 quad_perm:[2,3,0,1] row_mask:0xf bank_mask:0xf
    v_add_f32_dpp v12, v12, v12 quad_perm:[2,3,0,1] row_mask:0xf bank_mask:0xf
    v_add_f32_dpp v13, v13, v13 quad_perm:[2,3,0,1] row_mask:0xf bank_mask:0xf
    v_add_f32_dpp v14, v14, v14 quad_perm:[2,3,0,1] row_mask:0xf bank_mask:0xf
    v_add_f32_dpp v15, v15, v15 quad_perm:[2,3,0,1] row_mask:0xf bank_mask:0xf
    v_add_f32_dpp v8, v8, v8 row_half_mirror row_mask:0xf bank_mask:0xf
    v_add_f32_dpp v9, v9, v9 row_half_mirror row_mask:0xf bank_mask:0xf
    v_add_f32_dpp v10, v10, v10 row_half_mirror row_mask:0xf bank_mask:0xf
    v_add_f32_dpp v11, v11, v11 row_half_mirror row_mask:0xf bank_mask:0xf
    v_add_f32_dpp v12, v12, v12 row_half_mirror row_mask:0xf bank_mask:0xf
    v_add_f32_dpp v13, v13, v13 row_half_mirror row_mask:0xf bank_mask:0xf
    v_add_f32_dpp v14, v14, v14 row_half_mirror row_mask:0xf bank_mask:0xf
    v_add_f32_dpp v15, v15, v15 row_half_mirror row_mask:0xf bank_mask:0xf
    v_add_f32_dpp v8, v8, v8 row_mirror row_mask:0xf bank_mask:0xf
    v_add_f32_dpp v9, v9, v9 row_mirror row_mask:0xf bank_mask:0xf
    v_add_f32_dpp v10, v10, v10 row_mirror row_mask:0xf bank_mask:0xf
    v_add_f32_dpp v11, v11, v11 row_mirror row_mask:0xf bank_mask:0xf
    v_add_f32_dpp v12, v12, v12 row_mirror row_mask:0xf bank_mask:0xf
    v_add_f32_dpp v13, v13, v13 row_mirror row_mask:0xf bank_mask:0xf
    v_add_f32_dpp v14, v14, v14 row_mirror row_mask:0xf bank_mask:0xf
    v_add_f32_dpp v15, v15, v15 row_mirror row_mask:0xf bank_mask:0xf
    v_add_f32_dpp v8, v8, v8 row_bcast:15 row_mask:0xa bank_mask:0xf
    v_add_f32_dpp v9, v9, v9 row_bcast:15 row_mask:0xa bank_mask:0xf
    v_add_f32_dpp v10, v10, v10 row_bcast:15 row_mask:0xa bank_mask:0xf
    v_add_f32_dpp v11, v11, v11 row_bcast:15 row_mask:0xa bank_mask:0xf
    v_add_f32_dpp v12, v12, v12 row_bcast:15 row_mask:0xa bank_mask:0xf
    v_add_f32_dpp v13, v13, v13 row_bcast:15 row_mask:0xa bank_mask:0xf
    v_add_f32_dpp v14, v14, v14 row_bcast:15 row_mask:0xa bank_mask:0xf
    v_add_f32_dpp v15, v15, v15 row_bcast:15 row_mask:0xa bank_mask:0xf
    v_add_f32_dpp v8, v8, v8 row_bcast:31 row_mask:0xc bank_mask:0xf
    v_add_f32_dpp v9, v9, v9 row_bcast:31 row_mask:0xc bank_mask:0xf
    v_add_f32_dpp v10, v10, v10 row_bcast:31 row_mask:0xc bank_mask:0xf
    v_add_f32_dpp v11, v11, v11 row_bcast:31 row_mask:0xc bank_mask:0xf
    v_add_f32_dpp v12, v12, v12 row_bcast:31 row_mask:0xc bank_mask:0xf
    v_add_f32_dpp v13, v13, v13 row_bcast:31 row_mask:0xc bank_mask:0xf
    v_add_f32_dpp v14, v14, v14 row_bcast:31 row_mask:0xc bank_mask:0xf
    v_add_f32_dpp v15, v15, v15 row_bcast:31 row_mask:0xc bank_mask:0xf
    s_mov_b32 s48, 0x3b000000
    v_mul_f32 v8, s48, v8
    v_mul_f32 v9, s48, v9
    v_mul_f32 v10, s48, v10
    v_mul_f32 v11, s48, v11
    v_mul_f32 v12, s48, v12
    v_mul_f32 v13, s48, v13
    v_mul_f32 v14, s48, v14
    v_mul_f32 v15, s48, v15
    s_nop 0
    v_readlane_b32 s50, v8, 63
    v_readlane_b32 s51, v9, 63
    v_readlane_b32 s52, v10, 63
    v_readlane_b32 s53, v11, 63
    v_readlane_b32 s54, v12, 63
    v_readlane_b32 s55, v13, 63
    v_readlane_b32 s56, v14, 63
    v_readlane_b32 s57, v15, 63
    s_nop 1
    v_subrev_f32 v48, s50, v48
    v_subrev_f32 v49, s50, v49
    v_subrev_f32 v50, s50, v50
    v_subrev_f32 v51, s50, v51
    v_subrev_f32 v52, s50, v52
    v_subrev_f32 v53, s50, v53
    v_subrev_f32 v54, s50, v54
    v_subrev_f32 v55, s50, v55
    v_subrev_f32 v56, s51, v56
    v_subrev_f32 v57, s51, v57
    v_subrev_f32 v58, s51, v58
    v_subrev_f32 v59, s51, v59
    v_subrev_f32 v60, s51, v60
    v_subrev_f32 v61, s51, v61
    v_subrev_f32 v62, s51, v62
    v_subrev_f32 v63, s51, v63
    v_subrev_f32 v64, s52, v64
    v_subrev_f32 v65, s52, v65
    v_subrev_f32 v66, s52, v66
    v_subrev_f32 v67, s52, v67
    v_subrev_f32 v68, s52, v68
    v_subrev_f32 v69, s52, v69
    v_subrev_f32 v70, s52, v70
    v_subrev_f32 v71, s52, v71
    v_subrev_f32 v72, s53, v72
    v_subrev_f32 v73, s53, v73
    v_subrev_f32 v74, s53, v74
    v_subrev_f32 v75, s53, v75
    v_subrev_f32 v76, s53, v76
    v_subrev_f32 v77, s53, v77
    v_subrev_f32 v78, s53, v78
    v_subrev_f32 v79, s53, v79
    v_subrev_f32 v80, s54, v80
    v_subrev_f32 v81, s54, v81
    v_subrev_f32 v82, s54, v82
    v_subrev_f32 v83, s54, v83
    v_subrev_f32 v84, s54, v84
    v_subrev_f32 v85, s54, v85
    v_subrev_f32 v86, s54, v86
    v_subrev_f32 v87, s54, v87
    v_subrev_f32 v88, s55, v88
    v_subrev_f32 v89, s55, v89
    v_subrev_f32 v90, s55, v90
    v_subrev_f32 v91, s55, v91
    v_subrev_f32 v92, s55, v92
    v_subrev_f32 v93, s55, v93
    v_subrev_f32 v94, s55, v94
    v_subrev_f32 v95, s55, v95
    v_subrev_f32 v96, s56, v96
    v_subrev_f32 v97, s56, v97
    v_subrev_f32 v98, s56, v98
    v_subrev_f32 v99, s56, v99
    v_subrev_f32 v100, s56, v100
    v_subrev_f32 v101, s56, v101
    v_subrev_f32 v102, s56, v102
    v_subrev_f32 v103, s56, v103
    v_subrev_f32 v104, s57, v104
    v_subrev_f32 v105, s57, v105
    v_subrev_f32 v106, s57, v106
    v_subrev_f32 v107, s57, v107
    v_subrev_f32 v108, s57, v108
    v_subrev_f32 v109, s57, v109
    v_subrev_f32 v110, s57, v110
    v_subrev_f32 v111, s57, v111
    v_mul_f32 v8, v48, v48
    v_mul_f32 v9, v56, v56
    v_mul_f32 v10, v64, v64
    v_mul_f32 v11, v72, v72
    v_mul_f32 v12, v80, v80
    v_mul_f32 v13, v88, v88
    v_mul_f32 v14, v96, v96
    v_mul_f32 v15, v104, v104
    v_fmac_f32 v8, v49, v49
    v_fmac_f32 v9, v57, v57
    v_fmac_f32 v10, v65, v65
    v_fmac_f32 v11, v73, v73
    v_fmac_f32 v12, v81, v81
    v_fmac_f32 v13, v89, v89
    v_fmac_f32 v14, v97, v97
    v_fmac_f32 v15, v105, v105
    v_fmac_f32 v8, v50, v50
    v_fmac_f32 v9, v58, v58
    v_fmac_f32 v10, v66, v66
    v_fmac_f32 v11, v74, v74
    v_fmac_f32 v12, v82, v82
    v_fmac_f32 v13, v90, v90
    v_fmac_f32 v14, v98, v98
    v_fmac_f32 v15, v106, v106
    v_fmac_f32 v8, v51, v51
    v_fmac_f32 v9, v59, v59
    v_fmac_f32 v10, v67, v67
    v_fmac_f32 v11, v75, v75
    v_fmac_f32 v12, v83, v83
    v_fmac_f32 v13, v91, v91
    v_fmac_f32 v14, v99, v99
    v_fmac_f32 v15, v107, v107
    v_fmac_f32 v8, v52, v52
    v_fmac_f32 v9, v60, v60
    v_fmac_f32 v10, v68, v68
    v_fmac_f32 v11, v76, v76
    v_fmac_f32 v12, v84, v84
    v_fmac_f32 v13, v92, v92
    v_fmac_f32 v14, v100, v100
    v_fmac_f32 v15, v108, v108
    v_fmac_f32 v8, v53, v53
    v_fmac_f32 v9, v61, v61
    v_fmac_f32 v10, v69, v69
    v_fmac_f32 v11, v77, v77
    v_fmac_f32 v12, v85, v85
    v_fmac_f32 v13, v93, v93
    v_fmac_f32 v14, v101, v101
    v_fmac_f32 v15, v109, v109
    v_fmac_f32 v8, v54, v54
    v_fmac_f32 v9, v62, v62
    v_fmac_f32 v10, v70, v70
    v_fmac_f32 v11, v78, v78
    v_fmac_f32 v12, v86, v86
    v_fmac_f32 v13, v94, v94
    v_fmac_f32 v14, v102, v102
    v_fmac_f32 v15, v110, v110
    v_fmac_f32 v8, v55, v55
    v_fmac_f32 v9, v63, v63
    v_fmac_f32 v10, v71, v71
    v_fmac_f32 v11, v79, v79
    v_fmac_f32 v12, v87, v87
    v_fmac_f32 v13, v95, v95
    v_fmac_f32 v14, v103, v103
    v_fmac_f32 v15, v111, v111
    v_add_f32_dpp v8, v8, v8 quad_perm:[1,0,3,2] row_mask:0xf bank_mask:0xf
    v_add_f32_dpp v9, v9, v9 quad_perm:[1,0,3,2] row_mask:0xf bank_mask:0xf
    v_add_f32_dpp v10, v10, v10 quad_perm:[1,0,3,2] row_mask:0xf bank_mask:0xf
    v_add_f32_dpp v11, v11, v11 quad_perm:[1,0,3,2] row_mask:0xf bank_mask:0xf
    v_add_f32_dpp v12, v12, v12 quad_perm:[1,0,3,2] row_mask:0xf bank_mask:0xf
    v_add_f32_dpp v13, v13, v13 quad_perm:[1,0,3,2] row_mask:0xf bank_mask:0xf
    v_add_f32_dpp v14, v14, v14 quad_perm:[1,0,3,2] row_mask:0xf bank_mask:0xf
    v_add_f32_dpp v15, v15, v15 quad_perm:[1,0,3,2] row_mask:0xf bank_mask:0xf
    v_add_f32_dpp v8, v8, v8 quad_perm:[2,3,0,1] row_mask:0xf bank_mask:0xf
    v_add_f32_dpp v9, v9, v9 quad_perm:[2,3,0,1] row_mask:0xf bank_mask:0xf
    v_add_f32_dpp v10, v10, v10 quad_perm:[2,3,0,1] row_mask:0xf bank_mask:0xf
    v_add_f32_dpp v11, v11, v11 quad_perm:[2,3,0,1] row_mask:0xf bank_mask:0xf
    v_add_f32_dpp v12, v12, v12 quad_perm:[2,3,0,1] row_mask:0xf bank_mask:0xf
    v_add_f32_dpp v13, v13, v13 quad_perm:[2,3,0,1] row_mask:0xf bank_mask:0xf
    v_add_f32_dpp v14, v14, v14 quad_perm:[2,3,0,1] row_mask:0xf bank_mask:0xf
    v_add_f32_dpp v15, v15, v15 quad_perm:[2,3,0,1] row_mask:0xf bank_mask:0xf
    v_add_f32_dpp v8, v8, v8 row_half_mirror row_mask:0xf bank_mask:0xf
    v_add_f32_dpp v9, v9, v9 row_half_mirror row_mask:0xf bank_mask:0xf
    v_add_f32_dpp v10, v10, v10 row_half_mirror row_mask:0xf bank_mask:0xf
    v_add_f32_dpp v11, v11, v11 row_half_mirror row_mask:0xf bank_mask:0xf
    v_add_f32_dpp v12, v12, v12 row_half_mirror row_mask:0xf bank_mask:0xf
    v_add_f32_dpp v13, v13, v13 row_half_mirror row_mask:0xf bank_mask:0xf
    v_add_f32_dpp v14, v14, v14 row_half_mirror row_mask:0xf bank_mask:0xf
    v_add_f32_dpp v15, v15, v15 row_half_mirror row_mask:0xf bank_mask:0xf
    v_add_f32_dpp v8, v8, v8 row_mirror row_mask:0xf bank_mask:0xf
    v_add_f32_dpp v9, v9, v9 row_mirror row_mask:0xf bank_mask:0xf
    v_add_f32_dpp v10, v10, v10 row_mirror row_mask:0xf bank_mask:0xf
    v_add_f32_dpp v11, v11, v11 row_mirror row_mask:0xf bank_mask:0xf
    v_add_f32_dpp v12, v12, v12 row_mirror row_mask:0xf bank_mask:0xf
    v_add_f32_dpp v13, v13, v13 row_mirror row_mask:0xf bank_mask:0xf
    v_add_f32_dpp v14, v14, v14 row_mirror row_mask:0xf bank_mask:0xf
    v_add_f32_dpp v15, v15, v15 row_mirror row_mask:0xf bank_mask:0xf
    v_add_f32_dpp v8, v8, v8 row_bcast:15 row_mask:0xa bank_mask:0xf
    v_add_f32_dpp v9, v9, v9 row_bcast:15 row_mask:0xa bank_mask:0xf
    v_add_f32_dpp v10, v10, v10 row_bcast:15 row_mask:0xa bank_mask:0xf
    v_add_f32_dpp v11, v11, v11 row_bcast:15 row_mask:0xa bank_mask:0xf
    v_add_f32_dpp v12, v12, v12 row_bcast:15 row_mask:0xa bank_mask:0xf
    v_add_f32_dpp v13, v13, v13 row_bcast:15 row_mask:0xa bank_mask:0xf
    v_add_f32_dpp v14, v14, v14 row_bcast:15 row_mask:0xa bank_mask:0xf
    v_add_f32_dpp v15, v15, v15 row_bcast:15 row_mask:0xa bank_mask:0xf
    v_add_f32_dpp v8, v8, v8 row_bcast:31 row_mask:0xc bank_mask:0xf
    v_add_f32_dpp v9, v9, v9 row_bcast:31 row_mask:0xc bank_mask:0xf
    v_add_f32_dpp v10, v10, v10 row_bcast:31 row_mask:0xc bank_mask:0xf
    v_add_f32_dpp v11, v11, v11 row_bcast:31 row_mask:0xc bank_mask:0xf
    v_add_f32_dpp v12, v12, v12 row_bcast:31 row_mask:0xc bank_mask:0xf
    v_add_f32_dpp v13, v13, v13 row_bcast:31 row_mask:0xc bank_mask:0xf
    v_add_f32_dpp v14, v14, v14 row_bcast:31 row_mask:0xc bank_mask:0xf
    v_add_f32_dpp v15, v15, v15 row_bcast:31 row_mask:0xc bank_mask:0xf
    v_mov_b32 v5, 0x3727c5ac
    v_fma_f32 v8, v8, s48, v5
    v_fma_f32 v9, v9, s48, v5
    v_fma_f32 v10, v10, s48, v5
    v_fma_f32 v11, v11, s48, v5
    v_fma_f32 v12, v12, s48, v5
    v_fma_f32 v13, v13, s48, v5
    v_fma_f32 v14, v14, s48, v5
    v_fma_f32 v15, v15, s48, v5
    v_rsq_f32 v8, v8
    v_rsq_f32 v9, v9
    v_rsq_f32 v10, v10
    v_rsq_f32 v11, v11
    v_rsq_f32 v12, v12
    v_rsq_f32 v13, v13
    v_rsq_f32 v14, v14
    v_rsq_f32 v15, v15
    s_nop 0
    v_readlane_b32 s50, v8, 63
    v_readlane_b32 s51, v9, 63
    v_readlane_b32 s52, v10, 63
    v_readlane_b32 s53, v11, 63
    v_readlane_b32 s54, v12, 63
    v_readlane_b32 s55, v13, 63
    v_readlane_b32 s56, v14, 63
    v_readlane_b32 s57, v15, 63
    s_nop 1
    s_add_u32 s45, s45, 25165824
    s_add_u32 s47, s47, 25165824
    v_mul_f32 v48, s50, v48
    v_mul_f32 v49, s50, v49
    v_mul_f32 v50, s50, v50
    v_mul_f32 v51, s50, v51
    v_mul_f32 v52, s50, v52
    v_mul_f32 v53, s50, v53
    v_mul_f32 v54, s50, v54
    v_mul_f32 v55, s50, v55
    v_cvt_pk_bf16_f32 v16, v48, v49
    v_cvt_pk_bf16_f32 v17, v50, v51
    v_cvt_pk_bf16_f32 v18, v52, v53
    v_cvt_pk_bf16_f32 v19, v54, v55
    buffer_store_dwordx4 v[16:19], v3, s[8:11], s45 offen offset:0
    v_mul_f32 v56, s51, v56
    v_mul_f32 v57, s51, v57
    v_mul_f32 v58, s51, v58
    v_mul_f32 v59, s51, v59
    v_mul_f32 v60, s51, v60
    v_mul_f32 v61, s51, v61
    v_mul_f32 v62, s51, v62
    v_mul_f32 v63, s51, v63
    v_cvt_pk_bf16_f32 v20, v56, v57
    v_cvt_pk_bf16_f32 v21, v58, v59
    v_cvt_pk_bf16_f32 v22, v60, v61
    v_cvt_pk_bf16_f32 v23, v62, v63
    buffer_store_dwordx4 v[20:23], v3, s[8:11], s45 offen offset:1024
    v_mul_f32 v64, s52, v64
    v_mul_f32 v65, s52, v65
    v_mul_f32 v66, s52, v66
    v_mul_f32 v67, s52, v67
    v_mul_f32 v68, s52, v68
    v_mul_f32 v69, s52, v69
    v_mul_f32 v70, s52, v70
    v_mul_f32 v71, s52, v71
    v_cvt_pk_bf16_f32 v24, v64, v65
    v_cvt_pk_bf16_f32 v25, v66, v67
    v_cvt_pk_bf16_f32 v26, v68, v69
    v_cvt_pk_bf16_f32 v27, v70, v71
    buffer_store_dwordx4 v[24:27], v3, s[8:11], s45 offen offset:2048
    v_mul_f32 v72, s53, v72
    v_mul_f32 v73, s53, v73
    v_mul_f32 v74, s53, v74
    v_mul_f32 v75, s53, v75
    v_mul_f32 v76, s53, v76
    v_mul_f32 v77, s53, v77
    v_mul_f32 v78, s53, v78
    v_mul_f32 v79, s53, v79
    v_cvt_pk_bf16_f32 v28, v72, v73
    v_cvt_pk_bf16_f32 v29, v74, v75
    v_cvt_pk_bf16_f32 v30, v76, v77
    v_cvt_pk_bf16_f32 v31, v78, v79
    buffer_store_dwordx4 v[28:31], v3, s[8:11], s45 offen offset:3072
    v_mul_f32 v80, s54, v80
    v_mul_f32 v81, s54, v81
    v_mul_f32 v82, s54, v82
    v_mul_f32 v83, s54, v83
    v_mul_f32 v84, s54, v84
    v_mul_f32 v85, s54, v85
    v_mul_f32 v86, s54, v86
    v_mul_f32 v87, s54, v87
    v_cvt_pk_bf16_f32 v32, v80, v81
    v_cvt_pk_bf16_f32 v33, v82, v83
    v_cvt_pk_bf16_f32 v34, v84, v85
    v_cvt_pk_bf16_f32 v35, v86, v87
    buffer_store_dwordx4 v[32:35], v3, s[8:11], s47 offen offset:0
    v_mul_f32 v88, s55, v88
    v_mul_f32 v89, s55, v89
    v_mul_f32 v90, s55, v90
    v_mul_f32 v91, s55, v91
    v_mul_f32 v92, s55, v92
    v_mul_f32 v93, s55, v93
    v_mul_f32 v94, s55, v94
    v_mul_f32 v95, s55, v95
    v_cvt_pk_bf16_f32 v36, v88, v89
    v_cvt_pk_bf16_f32 v37, v90, v91
    v_cvt_pk_bf16_f32 v38, v92, v93
    v_cvt_pk_bf16_f32 v39, v94, v95
    buffer_store_dwordx4 v[36:39], v3, s[8:11], s47 offen offset:1024
    v_mul_f32 v96, s56, v96
    v_mul_f32 v97, s56, v97
    v_mul_f32 v98, s56, v98
    v_mul_f32 v99, s56, v99
    v_mul_f32 v100, s56, v100
    v_mul_f32 v101, s56, v101
    v_mul_f32 v102, s56, v102
    v_mul_f32 v103, s56, v103
    v_cvt_pk_bf16_f32 v40, v96, v97
    v_cvt_pk_bf16_f32 v41, v98, v99
    v_cvt_pk_bf16_f32 v42, v100, v101
    v_cvt_pk_bf16_f32 v43, v102, v103
    buffer_store_dwordx4 v[40:43], v3, s[8:11], s47 offen offset:2048
    v_mul_f32 v104, s57, v104
    v_mul_f32 v105, s57, v105
    v_mul_f32 v106, s57, v106
    v_mul_f32 v107, s57, v107
    v_mul_f32 v108, s57, v108
    v_mul_f32 v109, s57, v109
    v_mul_f32 v110, s57, v110
    v_mul_f32 v111, s57, v111
    v_cvt_pk_bf16_f32 v44, v104, v105
    v_cvt_pk_bf16_f32 v45, v106, v107
    v_cvt_pk_bf16_f32 v46, v108, v109
    v_cvt_pk_bf16_f32 v47, v110, v111
    buffer_store_dwordx4 v[44:47], v3, s[8:11], s47 offen offset:3072
    s_endpgm
k0_kernel_p_after_xp:
k0_kernel_end:
    s_endpgm
.globl k1_kernel
.p2align 8
.type k1_kernel,@function
k1_kernel:
    s_cmp_ge_u32 s2, 256
    s_cbranch_scc1 k1_kernel_end
    s_load_dwordx2 s[16:17], s[0:1], 0
    s_load_dwordx2 s[18:19], s[0:1], 104
    v_lshrrev_b32 v1, 6, v0
    v_and_b32 v2, 63, v0
    s_lshr_b32 s21, s2, 5
    s_bfe_u32 s22, s2, 0x20003
    s_and_b32 s23, s2, 7
    s_lshl_b32 s23, s23, 3
    s_add_u32 s21, s21, s23
    v_readfirstlane_b32 s3, v1
    v_lshlrev_b32 v3, 4, v2
    v_lshlrev_b32 v4, 5, v2
    s_waitcnt lgkmcnt(0)
    s_mov_b32 s4, s16
    s_and_b32 s5, s17, 0xffff
    s_mov_b32 s6, 2097152
    s_mov_b32 s7, 0x00020000
    s_mov_b32 s8, s18
    s_and_b32 s9, s19, 0xffff
    s_mov_b32 s10, 33554432
    s_mov_b32 s11, 0x00020000
    s_lshl_b32 s23, s21, 5
    s_lshl_b32 s24, s3, 3
    s_add_u32 s23, s23, s24
    s_lshl_b32 s23, s23, 10
    s_add_u32 s23, s23, 25165824
    buffer_load_dwordx4 v[16:19], v3, s[8:11], s23 offen offset:0
    buffer_load_dwordx4 v[20:23], v3, s[8:11], s23 offen offset:1024
    buffer_load_dwordx4 v[24:27], v3, s[8:11], s23 offen offset:2048
    buffer_load_dwordx4 v[28:31], v3, s[8:11], s23 offen offset:3072
    s_add_u32 s23, s23, 4096
    buffer_load_dwordx4 v[32:35], v3, s[8:11], s23 offen offset:0
    buffer_load_dwordx4 v[36:39], v3, s[8:11], s23 offen offset:1024
    buffer_load_dwordx4 v[40:43], v3, s[8:11], s23 offen offset:2048
    buffer_load_dwordx4 v[44:47], v3, s[8:11], s23 offen offset:3072
    s_mov_b32 s25, 131072
    buffer_load_dwordx4 v[112:115], v4, s[8:11], s25 offen
    buffer_load_dwordx4 v[116:119], v4, s[8:11], s25 offen offset:16
    buffer_load_dwordx4 v[120:123], v4, s[8:11], s25 offen offset:2048
    buffer_load_dwordx4 v[124:127], v4, s[8:11], s25 offen offset:2064
    s_lshl_b32 s26, s22, 2
    s_add_u32 s26, s26, s3
    s_lshl_b32 s27, s26, 15
    s_add_u32 s27, s27, 1048576
    buffer_load_dwordx4 v[128:131], v3, s[8:11], s27 offen offset:0
    buffer_load_dwordx4 v[132:135], v3, s[8:11], s27 offen offset:1024
    buffer_load_dwordx4 v[136:139], v3, s[8:11], s27 offen offset:2048
    buffer_load_dwordx4 v[140:143], v3, s[8:11], s27 offen offset:3072
    s_add_u32 s27, s27, 4096
    buffer_load_dwordx4 v[144:147], v3, s[8:11], s27 offen offset:0
    buffer_load_dwordx4 v[148:151], v3, s[8:11], s27 offen offset:1024
    buffer_load_dwordx4 v[152:155], v3, s[8:11], s27 offen offset:2048
    buffer_load_dwordx4 v[156:159], v3, s[8:11], s27 offen offset:3072
    s_add_u32 s27, s27, 4096
    s_waitcnt vmcnt(12)
    v_lshlrev_b32 v48, 16, v16
    v_and_b32 v49, 0xffff0000, v16
    v_lshlrev_b32 v50, 16, v17
    v_and_b32 v51, 0xffff0000, v17
    v_lshlrev_b32 v52, 16, v18
    v_and_b32 v53, 0xffff0000, v18
    v_lshlrev_b32 v54, 16, v19
    v_and_b32 v55, 0xffff0000, v19
    v_lshlrev_b32 v56, 16, v20
    v_and_b32 v57, 0xffff0000, v20
    v_lshlrev_b32 v58, 16, v21
    v_and_b32 v59, 0xffff0000, v21
    v_lshlrev_b32 v60, 16, v22
    v_and_b32 v61, 0xffff0000, v22
    v_lshlrev_b32 v62, 16, v23
    v_and_b32 v63, 0xffff0000, v23
    v_lshlrev_b32 v64, 16, v24
    v_and_b32 v65, 0xffff0000, v24
    v_lshlrev_b32 v66, 16, v25
    v_and_b32 v67, 0xffff0000, v25
    v_lshlrev_b32 v68, 16, v26
    v_and_b32 v69, 0xffff0000, v26
    v_lshlrev_b32 v70, 16, v27
    v_and_b32 v71, 0xffff0000, v27
    v_lshlrev_b32 v72, 16, v28
    v_and_b32 v73, 0xffff0000, v28
    v_lshlrev_b32 v74, 16, v29
    v_and_b32 v75, 0xffff0000, v29
    v_lshlrev_b32 v76, 16, v30
    v_and_b32 v77, 0xffff0000, v30
    v_lshlrev_b32 v78, 16, v31
    v_and_b32 v79, 0xffff0000, v31
    v_lshlrev_b32 v80, 16, v32
    v_and_b32 v81, 0xffff0000, v32
    v_lshlrev_b32 v82, 16, v33
    v_and_b32 v83, 0xffff0000, v33
    v_lshlrev_b32 v84, 16, v34
    v_and_b32 v85, 0xffff0000, v34
    v_lshlrev_b32 v86, 16, v35
    v_and_b32 v87, 0xffff0000, v35
    v_lshlrev_b32 v88, 16, v36
    v_and_b32 v89, 0xffff0000, v36
    v_lshlrev_b32 v90, 16, v37
    v_and_b32 v91, 0xffff0000, v37
    v_lshlrev_b32 v92, 16, v38
    v_and_b32 v93, 0xffff0000, v38
    v_lshlrev_b32 v94, 16, v39
    v_and_b32 v95, 0xffff0000, v39
    v_lshlrev_b32 v96, 16, v40
    v_and_b32 v97, 0xffff0000, v40
    v_lshlrev_b32 v98, 16, v41
    v_and_b32 v99, 0xffff0000, v41
    v_lshlrev_b32 v100, 16, v42
    v_and_b32 v101, 0xffff0000, v42
    v_lshlrev_b32 v102, 16, v43
    v_and_b32 v103, 0xffff0000, v43
    v_lshlrev_b32 v104, 16, v44
    v_and_b32 v105, 0xffff0000, v44
    v_lshlrev_b32 v106, 16, v45
    v_and_b32 v107, 0xffff0000, v45
    v_lshlrev_b32 v108, 16, v46
    v_and_b32 v109, 0xffff0000, v46
    v_lshlrev_b32 v110, 16, v47
    v_and_b32 v111, 0xffff0000, v47
    buffer_load_dwordx4 v[160:163], v3, s[8:11], s27 offen offset:0
    buffer_load_dwordx4 v[164:167], v3, s[8:11], s27 offen offset:1024
    buffer_load_dwordx4 v[168:171], v3, s[8:11], s27 offen offset:2048
    buffer_load_dwordx4 v[172:175], v3, s[8:11], s27 offen offset:3072
    s_add_u32 s27, s27, 4096
    buffer_load_dwordx4 v[176:179], v3, s[8:11], s27 offen offset:0
    buffer_load_dwordx4 v[180:183], v3, s[8:11], s27 offen offset:1024
    buffer_load_dwordx4 v[184:187], v3, s[8:11], s27 offen offset:2048
    buffer_load_dwordx4 v[188:191], v3, s[8:11], s27 offen offset:3072
    s_add_u32 s27, s27, 4096
    buffer_load_dwordx4 v[192:195], v3, s[8:11], s27 offen offset:0
    buffer_load_dwordx4 v[196:199], v3, s[8:11], s27 offen offset:1024
    buffer_load_dwordx4 v[200:203], v3, s[8:11], s27 offen offset:2048
    buffer_load_dwordx4 v[204:207], v3, s[8:11], s27 offen offset:3072
    s_add_u32 s27, s27, 4096
    s_waitcnt vmcnt(20)
    buffer_load_dwordx4 v[208:211], v3, s[8:11], s27 offen offset:0
    buffer_load_dwordx4 v[212:215], v3, s[8:11], s27 offen offset:1024
    buffer_load_dwordx4 v[216:219], v3, s[8:11], s27 offen offset:2048
    buffer_load_dwordx4 v[220:223], v3, s[8:11], s27 offen offset:3072
    s_add_u32 s27, s27, 4096
    buffer_load_dwordx4 v[224:227], v3, s[8:11], s27 offen offset:0
    buffer_load_dwordx4 v[228:231], v3, s[8:11], s27 offen offset:1024
    buffer_load_dwordx4 v[232:235], v3, s[8:11], s27 offen offset:2048
    buffer_load_dwordx4 v[236:239], v3, s[8:11], s27 offen offset:3072
    s_add_u32 s27, s27, 4096
    buffer_load_dwordx4 v[240:243], v3, s[8:11], s27 offen offset:0
    buffer_load_dwordx4 v[244:247], v3, s[8:11], s27 offen offset:1024
    buffer_load_dwordx4 v[248:251], v3, s[8:11], s27 offen offset:2048
    buffer_load_dwordx4 v[252:255], v3, s[8:11], s27 offen offset:3072
    s_add_u32 s27, s27, 4096
    s_lshl_b32 s27, s3, 13
    s_add_u32 s27, s27, 1572864
    buffer_load_dwordx4 v[16:19], v3, s[8:11], s27 offen offset:0
    buffer_load_dwordx4 v[20:23], v3, s[8:11], s27 offen offset:1024
    buffer_load_dwordx4 v[24:27], v3, s[8:11], s27 offen offset:2048
    buffer_load_dwordx4 v[28:31], v3, s[8:11], s27 offen offset:3072
    s_add_u32 s27, s27, 4096
    buffer_load_dwordx4 v[32:35], v3, s[8:11], s27 offen offset:0
    buffer_load_dwordx4 v[36:39], v3, s[8:11], s27 offen offset:1024
    buffer_load_dwordx4 v[40:43], v3, s[8:11], s27 offen offset:2048
    buffer_load_dwordx4 v[44:47], v3, s[8:11], s27 offen offset:3072
    v_add_f32 v120, 1.0, v120
    v_add_f32 v121, 1.0, v121
    v_add_f32 v122, 1.0, v122
    v_add_f32 v123, 1.0, v123
    v_add_f32 v124, 1.0, v124
    v_add_f32 v125, 1.0, v125
    v_add_f32 v126, 1.0, v126
    v_add_f32 v127, 1.0, v127
    v_cvt_pk_bf16_f32 v5, v120, v121
    v_lshlrev_b32 v120, 16, v5
    v_and_b32 v121, 0xffff0000, v5
    v_cvt_pk_bf16_f32 v5, v122, v123
    v_lshlrev_b32 v122, 16, v5
    v_and_b32 v123, 0xffff0000, v5
    v_cvt_pk_bf16_f32 v5, v124, v125
    v_lshlrev_b32 v124, 16, v5
    v_and_b32 v125, 0xffff0000, v5
    v_cvt_pk_bf16_f32 v5, v126, v127
    v_lshlrev_b32 v126, 16, v5
    v_and_b32 v127, 0xffff0000, v5
    v_lshrrev_b32 v6, 1, v2
    v_mul_u32_u24 v6, 1056, v6
    v_and_b32 v7, 1, v2
    v_mul_u32_u24 v7, 528, v7
    v_add_u32 v6, v6, v7
    s_lshl_b32 s24, s3, 7
    v_add_u32 v6, s24, v6
    v_fma_f32 v48, v48, v120, v112
    v_fma_f32 v49, v49, v121, v113
    v_fma_f32 v50, v50, v122, v114
    v_fma_f32 v51, v51, v123, v115
    v_fma_f32 v52, v52, v124, v116
    v_fma_f32 v53, v53, v125, v117
    v_fma_f32 v54, v54, v126, v118
    v_fma_f32 v55, v55, v127, v119
    v_cvt_pk_bf16_f32 v8, v48, v49
    v_cvt_pk_bf16_f32 v9, v50, v51
    v_cvt_pk_bf16_f32 v10, v52, v53
    v_cvt_pk_bf16_f32 v11, v54, v55
    ds_write_b128 v6, v[8:11] offset:0
    v_fma_f32 v56, v56, v120, v112
    v_fma_f32 v57, v57, v121, v113
    v_fma_f32 v58, v58, v122, v114
    v_fma_f32 v59, v59, v123, v115
    v_fma_f32 v60, v60, v124, v116
    v_fma_f32 v61, v61, v125, v117
    v_fma_f32 v62, v62, v126, v118
    v_fma_f32 v63, v63, v127, v119
    v_cvt_pk_bf16_f32 v12, v56, v57
    v_cvt_pk_bf16_f32 v13, v58, v59
    v_cvt_pk_bf16_f32 v14, v60, v61
    v_cvt_pk_bf16_f32 v15, v62, v63
    ds_write_b128 v6, v[12:15] offset:16
    v_fma_f32 v64, v64, v120, v112
    v_fma_f32 v65, v65, v121, v113
    v_fma_f32 v66, v66, v122, v114
    v_fma_f32 v67, v67, v123, v115
    v_fma_f32 v68, v68, v124, v116
    v_fma_f32 v69, v69, v125, v117
    v_fma_f32 v70, v70, v126, v118
    v_fma_f32 v71, v71, v127, v119
    v_cvt_pk_bf16_f32 v8, v64, v65
    v_cvt_pk_bf16_f32 v9, v66, v67
    v_cvt_pk_bf16_f32 v10, v68, v69
    v_cvt_pk_bf16_f32 v11, v70, v71
    ds_write_b128 v6, v[8:11] offset:32
    v_fma_f32 v72, v72, v120, v112
    v_fma_f32 v73, v73, v121, v113
    v_fma_f32 v74, v74, v122, v114
    v_fma_f32 v75, v75, v123, v115
    v_fma_f32 v76, v76, v124, v116
    v_fma_f32 v77, v77, v125, v117
    v_fma_f32 v78, v78, v126, v118
    v_fma_f32 v79, v79, v127, v119
    v_cvt_pk_bf16_f32 v12, v72, v73
    v_cvt_pk_bf16_f32 v13, v74, v75
    v_cvt_pk_bf16_f32 v14, v76, v77
    v_cvt_pk_bf16_f32 v15, v78, v79
    ds_write_b128 v6, v[12:15] offset:48
    v_fma_f32 v80, v80, v120, v112
    v_fma_f32 v81, v81, v121, v113
    v_fma_f32 v82, v82, v122, v114
    v_fma_f32 v83, v83, v123, v115
    v_fma_f32 v84, v84, v124, v116
    v_fma_f32 v85, v85, v125, v117
    v_fma_f32 v86, v86, v126, v118
    v_fma_f32 v87, v87, v127, v119
    v_cvt_pk_bf16_f32 v8, v80, v81
    v_cvt_pk_bf16_f32 v9, v82, v83
    v_cvt_pk_bf16_f32 v10, v84, v85
    v_cvt_pk_bf16_f32 v11, v86, v87
    ds_write_b128 v6, v[8:11] offset:64
    v_fma_f32 v88, v88, v120, v112
    v_fma_f32 v89, v89, v121, v113
    v_fma_f32 v90, v90, v122, v114
    v_fma_f32 v91, v91, v123, v115
    v_fma_f32 v92, v92, v124, v116
    v_fma_f32 v93, v93, v125, v117
    v_fma_f32 v94, v94, v126, v118
    v_fma_f32 v95, v95, v127, v119
    v_cvt_pk_bf16_f32 v12, v88, v89
    v_cvt_pk_bf16_f32 v13, v90, v91
    v_cvt_pk_bf16_f32 v14, v92, v93
    v_cvt_pk_bf16_f32 v15, v94, v95
    ds_write_b128 v6, v[12:15] offset:80
    v_fma_f32 v96, v96, v120, v112
    v_fma_f32 v97, v97, v121, v113
    v_fma_f32 v98, v98, v122, v114
    v_fma_f32 v99, v99, v123, v115
    v_fma_f32 v100, v100, v124, v116
    v_fma_f32 v101, v101, v125, v117
    v_fma_f32 v102, v102, v126, v118
    v_fma_f32 v103, v103, v127, v119
    v_cvt_pk_bf16_f32 v8, v96, v97
    v_cvt_pk_bf16_f32 v9, v98, v99
    v_cvt_pk_bf16_f32 v10, v100, v101
    v_cvt_pk_bf16_f32 v11, v102, v103
    ds_write_b128 v6, v[8:11] offset:96
    v_fma_f32 v104, v104, v120, v112
    v_fma_f32 v105, v105, v121, v113
    v_fma_f32 v106, v106, v122, v114
    v_fma_f32 v107, v107, v123, v115
    v_fma_f32 v108, v108, v124, v116
    v_fma_f32 v109, v109, v125, v117
    v_fma_f32 v110, v110, v126, v118
    v_fma_f32 v111, v111, v127, v119
    v_cvt_pk_bf16_f32 v12, v104, v105
    v_cvt_pk_bf16_f32 v13, v106, v107
    v_cvt_pk_bf16_f32 v14, v108, v109
    v_cvt_pk_bf16_f32 v15, v110, v111
    ds_write_b128 v6, v[12:15] offset:112
    s_waitcnt lgkmcnt(0)
    s_barrier
    v_lshrrev_b32 v6, 5, v2
    v_mul_u32_u24 v6, 528, v6
    v_and_b32 v7, 31, v2
    v_lshl_add_u32 v6, v7, 4, v6
    ds_read_b128 v[48:51], v6 offset:0
    ds_read_b128 v[52:55], v6 offset:1056
    ds_read_b128 v[56:59], v6 offset:2112
    ds_read_b128 v[60:63], v6 offset:3168
    ds_read_b128 v[64:67], v6 offset:4224
    ds_read_b128 v[68:71], v6 offset:5280
    ds_read_b128 v[72:75], v6 offset:6336
    ds_read_b128 v[76:79], v6 offset:7392
    ds_read_b128 v[80:83], v6 offset:8448
    ds_read_b128 v[84:87], v6 offset:9504
    ds_read_b128 v[88:91], v6 offset:10560
    ds_read_b128 v[92:95], v6 offset:11616
    ds_read_b128 v[96:99], v6 offset:12672
    ds_read_b128 v[100:103], v6 offset:13728
    ds_read_b128 v[104:107], v6 offset:14784
    ds_read_b128 v[108:111], v6 offset:15840
    s_waitcnt vmcnt(39) lgkmcnt(15)
    v_mfma_f32_32x32x16_bf16 v[112:127], v[128:131], v[48:51], 0
    ds_read_b128 v[48:51], v6 offset:16896
    s_waitcnt vmcnt(38) lgkmcnt(15)
    v_mfma_f32_32x32x16_bf16 v[112:127], v[132:135], v[52:55], v[112:127]
    ds_read_b128 v[52:55], v6 offset:17952
    s_waitcnt vmcnt(37) lgkmcnt(15)
    v_mfma_f32_32x32x16_bf16 v[112:127], v[136:139], v[56:59], v[112:127]
    ds_read_b128 v[56:59], v6 offset:19008
    s_waitcnt vmcnt(36) lgkmcnt(15)
    v_mfma_f32_32x32x16_bf16 v[112:127], v[140:143], v[60:63], v[112:127]
    ds_read_b128 v[60:63], v6 offset:20064
    s_waitcnt vmcnt(35) lgkmcnt(15)
    v_mfma_f32_32x32x16_bf16 v[112:127], v[144:147], v[64:67], v[112:127]
    ds_read_b128 v[64:67], v6 offset:21120
    s_waitcnt vmcnt(34) lgkmcnt(15)
    v_mfma_f32_32x32x16_bf16 v[112:127], v[148:151], v[68:71], v[112:127]
    ds_read_b128 v[68:71], v6 offset:22176
    s_waitcnt vmcnt(33) lgkmcnt(15)
    v_mfma_f32_32x32x16_bf16 v[112:127], v[152:155], v[72:75], v[112:127]
    ds_read_b128 v[72:75], v6 offset:23232
    s_waitcnt vmcnt(32) lgkmcnt(15)
    v_mfma_f32_32x32x16_bf16 v[112:127], v[156:159], v[76:79], v[112:127]
    ds_read_b128 v[76:79], v6 offset:24288
    s_waitcnt vmcnt(31) lgkmcnt(15)
    v_mfma_f32_32x32x16_bf16 v[112:127], v[160:163], v[80:83], v[112:127]
    ds_read_b128 v[80:83], v6 offset:25344
    s_waitcnt vmcnt(30) lgkmcnt(15)
    v_mfma_f32_32x32x16_bf16 v[112:127], v[164:167], v[84:87], v[112:127]
    ds_read_b128 v[84:87], v6 offset:26400
    s_waitcnt vmcnt(29) lgkmcnt(15)
    v_mfma_f32_32x32x16_bf16 v[112:127], v[168:171], v[88:91], v[112:127]
    ds_read_b128 v[88:91], v6 offset:27456
    s_waitcnt vmcnt(28) lgkmcnt(15)
    v_mfma_f32_32x32x16_bf16 v[112:127], v[172:175], v[92:95], v[112:127]
    ds_read_b128 v[92:95], v6 offset:28512
    s_waitcnt vmcnt(27) lgkmcnt(15)
    v_mfma_f32_32x32x16_bf16 v[112:127], v[176:179], v[96:99], v[112:127]
    ds_read_b128 v[96:99], v6 offset:29568
    s_waitcnt vmcnt(26) lgkmcnt(15)
    v_mfma_f32_32x32x16_bf16 v[112:127], v[180:183], v[100:103], v[112:127]
    ds_read_b128 v[100:103], v6 offset:30624
    s_waitcnt vmcnt(25) lgkmcnt(15)
    v_mfma_f32_32x32x16_bf16 v[112:127], v[184:187], v[104:107], v[112:127]
    ds_read_b128 v[104:107], v6 offset:31680
    s_waitcnt vmcnt(24) lgkmcnt(15)
    v_mfma_f32_32x32x16_bf16 v[112:127], v[188:191], v[108:111], v[112:127]
    ds_read_b128 v[108:111], v6 offset:32736
    s_waitcnt vmcnt(23) lgkmcnt(15)
    v_mfma_f32_32x32x16_bf16 v[112:127], v[192:195], v[48:51], v[112:127]
    s_waitcnt vmcnt(22) lgkmcnt(14)
    v_mfma_f32_32x32x16_bf16 v[112:127], v[196:199], v[52:55], v[112:127]
    s_waitcnt vmcnt(21) lgkmcnt(13)
    v_mfma_f32_32x32x16_bf16 v[112:127], v[200:203], v[56:59], v[112:127]
    s_waitcnt vmcnt(20) lgkmcnt(12)
    v_mfma_f32_32x32x16_bf16 v[112:127], v[204:207], v[60:63], v[112:127]
    s_waitcnt vmcnt(19) lgkmcnt(11)
    v_mfma_f32_32x32x16_bf16 v[112:127], v[208:211], v[64:67], v[112:127]
    s_waitcnt vmcnt(18) lgkmcnt(10)
    v_mfma_f32_32x32x16_bf16 v[112:127], v[212:215], v[68:71], v[112:127]
    s_waitcnt vmcnt(17) lgkmcnt(9)
    v_mfma_f32_32x32x16_bf16 v[112:127], v[216:219], v[72:75], v[112:127]
    s_waitcnt vmcnt(16) lgkmcnt(8)
    v_mfma_f32_32x32x16_bf16 v[112:127], v[220:223], v[76:79], v[112:127]
    s_waitcnt vmcnt(15) lgkmcnt(7)
    v_mfma_f32_32x32x16_bf16 v[112:127], v[224:227], v[80:83], v[112:127]
    s_waitcnt vmcnt(14) lgkmcnt(6)
    v_mfma_f32_32x32x16_bf16 v[112:127], v[228:231], v[84:87], v[112:127]
    s_waitcnt vmcnt(13) lgkmcnt(5)
    v_mfma_f32_32x32x16_bf16 v[112:127], v[232:235], v[88:91], v[112:127]
    s_waitcnt vmcnt(12) lgkmcnt(4)
    v_mfma_f32_32x32x16_bf16 v[112:127], v[236:239], v[92:95], v[112:127]
    s_waitcnt vmcnt(11) lgkmcnt(3)
    v_mfma_f32_32x32x16_bf16 v[112:127], v[240:243], v[96:99], v[112:127]
    s_waitcnt vmcnt(10) lgkmcnt(2)
    v_mfma_f32_32x32x16_bf16 v[112:127], v[244:247], v[100:103], v[112:127]
    s_waitcnt vmcnt(9) lgkmcnt(1)
    v_mfma_f32_32x32x16_bf16 v[112:127], v[248:251], v[104:107], v[112:127]
    s_waitcnt vmcnt(8) lgkmcnt(0)
    v_mfma_f32_32x32x16_bf16 v[112:127], v[252:255], v[108:111], v[112:127]
    s_nop 15
    s_nop 3
    s_mov_b32 s28, 0x3eb8aa3b
    v_mul_f32 v112, s28, v112
    v_mul_f32 v113, s28, v113
    v_mul_f32 v114, s28, v114
    v_mul_f32 v115, s28, v115
    v_mul_f32 v116, s28, v116
    v_mul_f32 v117, s28, v117
    v_mul_f32 v118, s28, v118
    v_mul_f32 v119, s28, v119
    v_mul_f32 v120, s28, v120
    v_mul_f32 v121, s28, v121
    v_mul_f32 v122, s28, v122
    v_mul_f32 v123, s28, v123
    v_mul_f32 v124, s28, v124
    v_mul_f32 v125, s28, v125
    v_mul_f32 v126, s28, v126
    v_mul_f32 v127, s28, v127
    v_cvt_pk_bf16_f32 v96, v112, v113
    v_cvt_pk_bf16_f32 v97, v114, v115
    v_cvt_pk_bf16_f32 v98, v116, v117
    v_cvt_pk_bf16_f32 v99, v118, v119
    v_cvt_pk_bf16_f32 v100, v120, v121
    v_cvt_pk_bf16_f32 v101, v122, v123
    v_cvt_pk_bf16_f32 v102, v124, v125
    v_cvt_pk_bf16_f32 v103, v126, v127
    s_nop 1
    v_permlane32_swap_b32 v96, v98
    v_permlane32_swap_b32 v97, v99
    v_permlane32_swap_b32 v100, v102
    v_permlane32_swap_b32 v101, v103
    v_and_b32 v7, 31, v2
    v_lshlrev_b32 v7, 10, v7
    v_lshrrev_b32 v8, 5, v2
    v_lshl_add_u32 v7, v8, 4, v7
    s_lshl_b32 s29, s21, 15
    s_lshl_b32 s30, s26, 6
    s_add_u32 s29, s29, s30
    s_add_u32 s29, s29, 9437184
    buffer_store_dwordx4 v[96:99], v7, s[8:11], s29 offen
    buffer_store_dwordx4 v[100:103], v7, s[8:11], s29 offen offset:32
    s_cmp_lg_u32 s22, 0
    s_cbranch_scc1 k1_kernel_end
    s_mul_i32 s28, s3, 8448
    v_add_u32 v6, s28, v6
    ds_read_b128 v[48:51], v6 offset:0
    ds_read_b128 v[52:55], v6 offset:1056
    ds_read_b128 v[56:59], v6 offset:2112
    ds_read_b128 v[60:63], v6 offset:3168
    ds_read_b128 v[64:67], v6 offset:4224
    ds_read_b128 v[68:71], v6 offset:5280
    ds_read_b128 v[72:75], v6 offset:6336
    ds_read_b128 v[76:79], v6 offset:7392
    s_waitcnt vmcnt(2)
    s_waitcnt lgkmcnt(7)
    v_mfma_f32_32x32x16_bf16 v[112:127], v[16:19], v[48:51], 0
    s_waitcnt lgkmcnt(6)
    v_mfma_f32_32x32x16_bf16 v[112:127], v[20:23], v[52:55], v[112:127]
    s_waitcnt lgkmcnt(5)
    v_mfma_f32_32x32x16_bf16 v[112:127], v[24:27], v[56:59], v[112:127]
    s_waitcnt lgkmcnt(4)
    v_mfma_f32_32x32x16_bf16 v[112:127], v[28:31], v[60:63], v[112:127]
    s_waitcnt lgkmcnt(3)
    v_mfma_f32_32x32x16_bf16 v[112:127], v[32:35], v[64:67], v[112:127]
    s_waitcnt lgkmcnt(2)
    v_mfma_f32_32x32x16_bf16 v[112:127], v[36:39], v[68:71], v[112:127]
    s_waitcnt lgkmcnt(1)
    v_mfma_f32_32x32x16_bf16 v[112:127], v[40:43], v[72:75], v[112:127]
    s_waitcnt lgkmcnt(0)
    v_mfma_f32_32x32x16_bf16 v[112:127], v[44:47], v[76:79], v[112:127]
    s_nop 15
    s_nop 3
    s_lshl_b32 s28, s3, 12
    v_add_u32 v6, s28, v3
    ds_write_b128 v6, v[112:115] offset:34816
    ds_write_b128 v6, v[116:119] offset:35840
    ds_write_b128 v6, v[120:123] offset:36864
    ds_write_b128 v6, v[124:127] offset:37888
    s_waitcnt lgkmcnt(0)
    s_barrier
    s_cmp_lg_u32 s3, 0
    s_cbranch_scc1 k1_kernel_end
    ds_read_b128 v[48:51], v3 offset:38912
    ds_read_b128 v[52:55], v3 offset:39936
    ds_read_b128 v[56:59], v3 offset:40960
    ds_read_b128 v[60:63], v3 offset:41984
    ds_read_b128 v[64:67], v3 offset:43008
    ds_read_b128 v[68:71], v3 offset:44032
    ds_read_b128 v[72:75], v3 offset:45056
    ds_read_b128 v[76:79], v3 offset:46080
    ds_read_b128 v[80:83], v3 offset:47104
    ds_read_b128 v[84:87], v3 offset:48128
    ds_read_b128 v[88:91], v3 offset:49152
    ds_read_b128 v[92:95], v3 offset:50176
    s_waitcnt lgkmcnt(0)
    v_add_f32 v112, v112, v48
    v_add_f32 v113, v113, v49
    v_add_f32 v114, v114, v50
    v_add_f32 v115, v115, v51
    v_add_f32 v116, v116, v52
    v_add_f32 v117, v117, v53
    v_add_f32 v118, v118, v54
    v_add_f32 v119, v119, v55
    v_add_f32 v120, v120, v56
    v_add_f32 v121, v121, v57
    v_add_f32 v122, v122, v58
    v_add_f32 v123, v123, v59
    v_add_f32 v124, v124, v60
    v_add_f32 v125, v125, v61
    v_add_f32 v126, v126, v62
    v_add_f32 v127, v127, v63
    v_add_f32 v112, v112, v64
    v_add_f32 v113, v113, v65
    v_add_f32 v114, v114, v66
    v_add_f32 v115, v115, v67
    v_add_f32 v116, v116, v68
    v_add_f32 v117, v117, v69
    v_add_f32 v118, v118, v70
    v_add_f32 v119, v119, v71
    v_add_f32 v120, v120, v72
    v_add_f32 v121, v121, v73
    v_add_f32 v122, v122, v74
    v_add_f32 v123, v123, v75
    v_add_f32 v124, v124, v76
    v_add_f32 v125, v125, v77
    v_add_f32 v126, v126, v78
    v_add_f32 v127, v127, v79
    v_add_f32 v112, v112, v80
    v_add_f32 v113, v113, v81
    v_add_f32 v114, v114, v82
    v_add_f32 v115, v115, v83
    v_add_f32 v116, v116, v84
    v_add_f32 v117, v117, v85
    v_add_f32 v118, v118, v86
    v_add_f32 v119, v119, v87
    v_add_f32 v120, v120, v88
    v_add_f32 v121, v121, v89
    v_add_f32 v122, v122, v90
    v_add_f32 v123, v123, v91
    v_add_f32 v124, v124, v92
    v_add_f32 v125, v125, v93
    v_add_f32 v126, v126, v94
    v_add_f32 v127, v127, v95
    v_cvt_pk_bf16_f32 v32, v112, v113
    v_cvt_pk_bf16_f32 v33, v114, v115
    v_cvt_pk_bf16_f32 v34, v116, v117
    v_cvt_pk_bf16_f32 v35, v118, v119
    v_cvt_pk_bf16_f32 v36, v120, v121
    v_cvt_pk_bf16_f32 v37, v122, v123
    v_cvt_pk_bf16_f32 v38, v124, v125
    v_cvt_pk_bf16_f32 v39, v126, v127
    s_nop 1
    v_permlane32_swap_b32 v32, v34
    v_permlane32_swap_b32 v33, v35
    s_lshl_b32 s29, s21, 10
    s_add_u32 s30, s29, 11534336
    buffer_store_dwordx4 v[32:35], v3, s[8:11], s30 offen
    v_bfe_u32 v7, v2, 4, 1
    v_lshlrev_b32 v7, 9, v7
    v_bfe_u32 v8, v2, 2, 1
    v_lshl_add_u32 v7, v8, 8, v7
    v_and_b32 v8, 3, v2
    v_lshl_add_u32 v7, v8, 1, v7
    v_bfe_u32 v8, v2, 3, 1
    v_lshl_add_u32 v7, v8, 3, v7
    v_lshrrev_b32 v8, 5, v2
    v_lshl_add_u32 v7, v8, 6, v7
    s_add_u32 s30, s29, 11599872
    buffer_store_short v36, v7, s[8:11], s30 offen offset:0
    buffer_store_short_d16_hi v36, v7, s[8:11], s30 offen offset:16
    buffer_store_short v37, v7, s[8:11], s30 offen offset:32
    buffer_store_short_d16_hi v37, v7, s[8:11], s30 offen offset:48
    buffer_store_short v38, v7, s[8:11], s30 offen offset:128
    buffer_store_short_d16_hi v38, v7, s[8:11], s30 offen offset:144
    buffer_store_short v39, v7, s[8:11], s30 offen offset:160
    buffer_store_short_d16_hi v39, v7, s[8:11], s30 offen offset:176
k1_kernel_end:
    s_endpgm
.globl k2_kernel
.p2align 8
.type k2_kernel,@function
k2_kernel:
    s_cmp_ge_u32 s2, 256
    s_cbranch_scc1 k2_kernel_end
    s_load_dwordx2 s[16:17], s[0:1], 0
    s_load_dwordx2 s[18:19], s[0:1], 104
    s_load_dwordx4 s[52:55], s[0:1], 48
    s_load_dwordx2 s[56:57], s[0:1], 64
    v_lshrrev_b32 v13, 6, v0
    v_and_b32 v2, 63, v0
    s_nop 0
    v_readfirstlane_b32 s3, v13
    v_lshlrev_b32 v3, 4, v2
    s_waitcnt lgkmcnt(0)
    s_mov_b32 s4, s16
    s_and_b32 s5, s17, 0xffff
    s_mov_b32 s6, 2097152
    s_mov_b32 s7, 0x00020000
    s_mov_b32 s8, s18
    s_and_b32 s9, s19, 0xffff
    s_mov_b32 s10, 33554432
    s_mov_b32 s11, 0x00020000
    s_mov_b32 s60, s52
    s_and_b32 s61, s53, 0xffff
    s_mov_b32 s62, 1835008
    s_mov_b32 s63, 0x00020000
    s_mov_b32 s64, s54
    s_and_b32 s65, s55, 0xffff
    s_mov_b32 s66, 1835008
    s_mov_b32 s67, 0x00020000
    s_mov_b32 s12, s56
    s_and_b32 s13, s57, 0xffff
    s_mov_b32 s14, 1835008
    s_mov_b32 s15, 0x00020000
    s_and_b32 s45, s3, 3
    s_lshr_b32 s46, s3, 2
    s_lshl_b32 s22, s2, 3
    s_lshl_b32 s23, s45, 1
    s_add_u32 s22, s22, s23
    s_lshl_b32 s23, s22, 10
    s_add_u32 s23, s23, 9437184
    v_bfe_u32 v13, v2, 4, 1
    v_lshlrev_b32 v13, 10, v13
    v_and_b32 v14, 15, v2
    v_lshl_add_u32 v13, v14, 5, v13
    v_lshrrev_b32 v15, 5, v2
    v_lshl_add_u32 v13, v15, 4, v13
    buffer_load_dwordx4 v[4:7], v13, s[8:11], s23 offen
    buffer_load_dwordx4 v[8:11], v13, s[8:11], s23 offen offset:512
    s_lshr_b32 s20, s3, 1
    s_lshl_b32 s20, s20, 15
    s_and_b32 s21, s3, 1
    s_lshl_b32 s21, s21, 12
    s_add_u32 s20, s20, s21
    s_add_u32 s21, s20, 11534336
    s_mov_b32 m0, s20
    s_nop 0
    buffer_load_dwordx4 v3, s[8:11], s21 offen offset:0 lds
    buffer_load_dwordx4 v3, s[8:11], s21 offen offset:1024 lds
    buffer_load_dwordx4 v3, s[8:11], s21 offen offset:2048 lds
    buffer_load_dwordx4 v3, s[8:11], s21 offen offset:3072 lds
    s_lshr_b32 s50, s3, 1
    s_lshl_b32 s50, s50, 15
    s_and_b32 s21, s3, 1
    s_mul_i32 s21, s21, 12288
    s_add_u32 s50, s50, s21
    s_add_u32 s50, s50, 8192
    s_lshl_b32 s51, s3, 10
    s_lshl_b32 s37, s2, 13
    v_lshl_add_u32 v14, v15, 4, v14
    v_lshlrev_b32 v99, 4, v14
    s_mov_b32 s30, 0x0000ffff
    s_mov_b32 s31, 0x0000ffff
    s_mov_b32 s27, 0x71800000
    s_mov_b32 s28, 0x44800000
    s_mov_b32 s47, 0
    s_mov_b32 s58, 0
    s_mov_b32 s59, 0
    v_mov_b32 v104, 0x3f803f80
    v_mov_b32 v105, 0x3f803f80
    v_mov_b32 v106, 0x3f803f80
    v_mov_b32 v107, 0x3f803f80
    v_mov_b32 v108, 0x3f803f80
    v_mov_b32 v109, 0x3f803f80
    v_mov_b32 v110, 0x3f803f80
    v_mov_b32 v111, 0x3f803f80
    s_waitcnt vmcnt(0)
    s_barrier
k2_kernel_round:
    s_lshl_b32 s20, s46, 15
    v_add_u32 v97, s20, v3
    s_add_u32 s21, s20, 65536
    v_add_u32 v98, s21, v99
    s_lshl_b32 s32, s3, 16
    s_lshl_b32 s33, s47, 13
    s_add_u32 s32, s32, s33
    s_add_u32 s32, s32, 2097152
    s_mov_b32 s25, 0
    s_cmp_eq_u32 s46, 0
    s_cbranch_scc1 k2_kernel_noprio
    s_setprio 1
k2_kernel_noprio:
    v_mov_b32 v72, 0
    v_mov_b32 v88, 0
    v_mov_b32 v73, 0
    v_mov_b32 v89, 0
    v_mov_b32 v74, 0
    v_mov_b32 v90, 0
    v_mov_b32 v75, 0
    v_mov_b32 v91, 0
    v_mov_b32 v76, 0
    v_mov_b32 v92, 0
    v_mov_b32 v77, 0
    v_mov_b32 v93, 0
    v_mov_b32 v78, 0
    v_mov_b32 v94, 0
    v_mov_b32 v79, 0
    v_mov_b32 v95, 0
    v_mov_b32 v80, 0
    v_mov_b32 v96, 0
    v_mov_b32 v13, 0xff7fffff
    ds_read_b128 v[100:103], v97 offset:0
    ds_read_b128 v[64:67], v97 offset:1024
    s_waitcnt lgkmcnt(1)
    v_mfma_f32_32x32x16_bf16 v[32:47], v[100:103], v[4:7], 0
    s_waitcnt lgkmcnt(0)
    v_mfma_f32_32x32x16_bf16 v[48:63], v[64:67], v[4:7], 0
    s_nop 11
    v_max3_f32 v13, v32, v33, v13
    v_max3_f32 v13, v34, v35, v13
    v_max3_f32 v13, v36, v37, v13
    v_max3_f32 v13, v38, v39, v13
    v_max3_f32 v13, v40, v41, v13
    v_max3_f32 v13, v42, v43, v13
    v_max3_f32 v13, v44, v45, v13
    v_max3_f32 v13, v46, v47, v13
    s_nop 3
    v_max3_f32 v13, v48, v49, v13
    v_max3_f32 v13, v50, v51, v13
    v_max3_f32 v13, v52, v53, v13
    v_max3_f32 v13, v54, v55, v13
    v_max3_f32 v13, v56, v57, v13
    v_max3_f32 v13, v58, v59, v13
    v_max3_f32 v13, v60, v61, v13
    v_max3_f32 v13, v62, v63, v13
    ds_read_b128 v[100:103], v97 offset:2048
    ds_read_b128 v[64:67], v97 offset:3072
    s_waitcnt lgkmcnt(1)
    v_mfma_f32_32x32x16_bf16 v[32:47], v[100:103], v[4:7], 0
    s_waitcnt lgkmcnt(0)
    v_mfma_f32_32x32x16_bf16 v[48:63], v[64:67], v[4:7], 0
    s_nop 11
    v_max3_f32 v13, v32, v33, v13
    v_max3_f32 v13, v34, v35, v13
    v_max3_f32 v13, v36, v37, v13
    v_max3_f32 v13, v38, v39, v13
    v_max3_f32 v13, v40, v41, v13
    v_max3_f32 v13, v42, v43, v13
    v_max3_f32 v13, v44, v45, v13
    v_max3_f32 v13, v46, v47, v13
    s_nop 3
    v_max3_f32 v13, v48, v49, v13
    v_max3_f32 v13, v50, v51, v13
    v_max3_f32 v13, v52, v53, v13
    v_max3_f32 v13, v54, v55, v13
    v_max3_f32 v13, v56, v57, v13
    v_max3_f32 v13, v58, v59, v13
    v_max3_f32 v13, v60, v61, v13
    v_max3_f32 v13, v62, v63, v13
    v_mov_b32 v14, v13
    s_nop 1
    v_permlane32_swap_b32 v14, v13
    s_nop 1
    v_max_f32 v13, v14, v13
    v_ceil_f32 v13, v13
    v_add_f32 v13, 0x42700000, v13
    v_sub_f32 v16, 0, v13
    v_mov_b32 v17, v16
    v_mov_b32 v18, v16
    v_mov_b32 v19, v16
    v_mov_b32 v20, v16
    v_mov_b32 v21, v16
    v_mov_b32 v22, v16
    v_mov_b32 v23, v16
    v_mov_b32 v24, v16
    v_mov_b32 v25, v16
    v_mov_b32 v26, v16
    v_mov_b32 v27, v16
    v_mov_b32 v28, v16
    v_mov_b32 v29, v16
    v_mov_b32 v30, v16
    v_mov_b32 v31, v16
    s_mov_b32 s24, 0
    s_branch k2_kernel_reinit
k2_kernel_restart0:
    v_exp_f32 v32, v32
    v_exp_f32 v33, v33
    v_exp_f32 v34, v34
    v_exp_f32 v35, v35
    v_cvt_pk_bf16_f32 v64, v32, v33
    v_cvt_pk_bf16_f32 v65, v34, v35
    s_waitcnt lgkmcnt(2)
    v_mfma_f32_32x32x16_bf16 v[48:63], v[100:103], v[4:7], v[16:31]
    ds_read_b128 v[100:103], v97 offset:2048
    s_cmp_lg_u32 s47, 0
    s_cbranch_scc1 k2_kernel_r1op0
    s_add_u32 s20, s50, 0
    s_mov_b32 m0, s20
    s_add_u32 s21, s20, 11534336
    buffer_load_dwordx4 v3, s[8:11], s21 offen lds
    s_add_u32 s20, s50, 1024
    s_mov_b32 m0, s20
    s_add_u32 s21, s20, 11534336
    buffer_load_dwordx4 v3, s[8:11], s21 offen lds
    s_add_u32 s20, s50, 2048
    s_mov_b32 m0, s20
    s_add_u32 s21, s20, 11534336
    buffer_load_dwordx4 v3, s[8:11], s21 offen lds
    s_branch k2_kernel_opdone0
k2_kernel_r1op0:
k2_kernel_opdone0:
    v_exp_f32 v36, v36
    v_exp_f32 v37, v37
    v_exp_f32 v38, v38
    v_exp_f32 v39, v39
    v_cvt_pk_bf16_f32 v66, v36, v37
    v_cvt_pk_bf16_f32 v67, v38, v39
    v_exp_f32 v40, v40
    v_exp_f32 v41, v41
    v_exp_f32 v42, v42
    v_exp_f32 v43, v43
    s_waitcnt lgkmcnt(1)
    v_mfma_f32_32x32x16_bf16 v[72:87], v[104:107], v[64:67], v[72:87]
    v_cvt_pk_bf16_f32 v68, v40, v41
    v_cvt_pk_bf16_f32 v69, v42, v43
    v_exp_f32 v44, v44
    v_exp_f32 v45, v45
    v_exp_f32 v46, v46
    v_exp_f32 v47, v47
    v_cvt_pk_bf16_f32 v70, v44, v45
    v_cvt_pk_bf16_f32 v71, v46, v47
    s_add_u32 s33, s32, 0
    buffer_load_dwordx4 v[128:131], v3, s[8:11], s33 offen offset:0
    v_mfma_f32_32x32x16_bf16 v[72:87], v[108:111], v[68:71], v[72:87]
    s_mov_b64 exec, s[30:31]
    ds_read_b128 v[104:107], v98 offset:1024
    ds_read_b128 v[108:111], v98 offset:1536
    s_mov_b64 exec, -1
    v_exp_f32 v48, v48
    v_exp_f32 v49, v49
    v_exp_f32 v50, v50
    v_exp_f32 v51, v51
    v_cvt_pk_bf16_f32 v64, v48, v49
    v_cvt_pk_bf16_f32 v65, v50, v51
    s_waitcnt lgkmcnt(2)
    v_mfma_f32_32x32x16_bf16 v[32:47], v[100:103], v[4:7], v[16:31]
    ds_read_b128 v[100:103], v97 offset:3072
    s_cmp_lg_u32 s47, 0
    s_cbranch_scc1 k2_kernel_r1op1
    s_add_u32 s20, s50, 3072
    s_mov_b32 m0, s20
    s_add_u32 s21, s20, 11534336
    buffer_load_dwordx4 v3, s[8:11], s21 offen lds
    s_add_u32 s20, s50, 4096
    s_mov_b32 m0, s20
    s_add_u32 s21, s20, 11534336
    buffer_load_dwordx4 v3, s[8:11], s21 offen lds
    s_add_u32 s20, s50, 5120
    s_mov_b32 m0, s20
    s_add_u32 s21, s20, 11534336
    buffer_load_dwordx4 v3, s[8:11], s21 offen lds
    s_branch k2_kernel_opdone1
k2_kernel_r1op1:
k2_kernel_opdone1:
    v_exp_f32 v52, v52
    v_exp_f32 v53, v53
    v_exp_f32 v54, v54
    v_exp_f32 v55, v55
    v_cvt_pk_bf16_f32 v66, v52, v53
    v_cvt_pk_bf16_f32 v67, v54, v55
    v_exp_f32 v56, v56
    v_exp_f32 v57, v57
    v_exp_f32 v58, v58
    v_exp_f32 v59, v59
    s_waitcnt lgkmcnt(1)
    v_mfma_f32_32x32x16_bf16 v[72:87], v[104:107], v[64:67], v[72:87]
    v_cvt_pk_bf16_f32 v68, v56, v57
    v_cvt_pk_bf16_f32 v69, v58, v59
    v_exp_f32 v60, v60
    v_exp_f32 v61, v61
    v_exp_f32 v62, v62
    v_exp_f32 v63, v63
    v_cvt_pk_bf16_f32 v70, v60, v61
    v_cvt_pk_bf16_f32 v71, v62, v63
    s_add_u32 s33, s32, 0
    buffer_load_dwordx4 v[132:135], v3, s[8:11], s33 offen offset:1024
    v_mfma_f32_32x32x16_bf16 v[72:87], v[108:111], v[68:71], v[72:87]
    s_mov_b64 exec, s[30:31]
    ds_read_b128 v[104:107], v98 offset:2048
    ds_read_b128 v[108:111], v98 offset:2560
    s_mov_b64 exec, -1
    v_exp_f32 v32, v32
    v_exp_f32 v33, v33
    v_exp_f32 v34, v34
    v_exp_f32 v35, v35
    v_cvt_pk_bf16_f32 v64, v32, v33
    v_cvt_pk_bf16_f32 v65, v34, v35
    s_waitcnt lgkmcnt(2)
    v_mfma_f32_32x32x16_bf16 v[48:63], v[100:103], v[4:7], v[16:31]
    ds_read_b128 v[100:103], v97 offset:4096
    s_cmp_lg_u32 s47, 0
    s_cbranch_scc1 k2_kernel_r1op2
    s_add_u32 s20, s50, 6144
    s_mov_b32 m0, s20
    s_add_u32 s21, s20, 11534336
    buffer_load_dwordx4 v3, s[8:11], s21 offen lds
    s_add_u32 s20, s50, 7168
    s_mov_b32 m0, s20
    s_add_u32 s21, s20, 11534336
    buffer_load_dwordx4 v3, s[8:11], s21 offen lds
    s_add_u32 s20, s50, 8192
    s_mov_b32 m0, s20
    s_add_u32 s21, s20, 11534336
    buffer_load_dwordx4 v3, s[8:11], s21 offen lds
    s_branch k2_kernel_opdone2
k2_kernel_r1op2:
k2_kernel_opdone2:
    v_exp_f32 v36, v36
    v_exp_f32 v37, v37
    v_exp_f32 v38, v38
    v_exp_f32 v39, v39
    v_cvt_pk_bf16_f32 v66, v36, v37
    v_cvt_pk_bf16_f32 v67, v38, v39
    v_exp_f32 v40, v40
    v_exp_f32 v41, v41
    v_exp_f32 v42, v42
    v_exp_f32 v43, v43
    s_waitcnt lgkmcnt(1)
    v_mfma_f32_32x32x16_bf16 v[72:87], v[104:107], v[64:67], v[72:87]
    v_cvt_pk_bf16_f32 v68, v40, v41
    v_cvt_pk_bf16_f32 v69, v42, v43
    v_exp_f32 v44, v44
    v_exp_f32 v45, v45
    v_exp_f32 v46, v46
    v_exp_f32 v47, v47
    v_cvt_pk_bf16_f32 v70, v44, v45
    v_cvt_pk_bf16_f32 v71, v46, v47
    s_add_u32 s33, s32, 0
    buffer_load_dwordx4 v[136:139], v3, s[8:11], s33 offen offset:2048
    v_mfma_f32_32x32x16_bf16 v[72:87], v[108:111], v[68:71], v[72:87]
    s_mov_b64 exec, s[30:31]
    ds_read_b128 v[104:107], v98 offset:3072
    ds_read_b128 v[108:111], v98 offset:3584
    s_mov_b64 exec, -1
    v_exp_f32 v48, v48
    v_exp_f32 v49, v49
    v_exp_f32 v50, v50
    v_exp_f32 v51, v51
    v_cvt_pk_bf16_f32 v64, v48, v49
    v_cvt_pk_bf16_f32 v65, v50, v51
    s_waitcnt lgkmcnt(2)
    v_mfma_f32_32x32x16_bf16 v[32:47], v[100:103], v[4:7], v[16:31]
    ds_read_b128 v[100:103], v97 offset:5120
    s_cmp_lg_u32 s47, 0
    s_cbranch_scc1 k2_kernel_r1op3
    s_add_u32 s20, s50, 9216
    s_mov_b32 m0, s20
    s_add_u32 s21, s20, 11534336
    buffer_load_dwordx4 v3, s[8:11], s21 offen lds
    s_add_u32 s20, s50, 10240
    s_mov_b32 m0, s20
    s_add_u32 s21, s20, 11534336
    buffer_load_dwordx4 v3, s[8:11], s21 offen lds
    s_add_u32 s20, s50, 11264
    s_mov_b32 m0, s20
    s_add_u32 s21, s20, 11534336
    buffer_load_dwordx4 v3, s[8:11], s21 offen lds
    s_branch k2_kernel_opdone3
k2_kernel_r1op3:
k2_kernel_opdone3:
    v_exp_f32 v52, v52
    v_exp_f32 v53, v53
    v_exp_f32 v54, v54
    v_exp_f32 v55, v55
    v_cvt_pk_bf16_f32 v66, v52, v53
    v_cvt_pk_bf16_f32 v67, v54, v55
    v_exp_f32 v56, v56
    v_exp_f32 v57, v57
    v_exp_f32 v58, v58
    v_exp_f32 v59, v59
    s_waitcnt lgkmcnt(1)
    v_mfma_f32_32x32x16_bf16 v[72:87], v[104:107], v[64:67], v[72:87]
    v_cvt_pk_bf16_f32 v68, v56, v57
    v_cvt_pk_bf16_f32 v69, v58, v59
    v_exp_f32 v60, v60
    v_exp_f32 v61, v61
    v_exp_f32 v62, v62
    v_exp_f32 v63, v63
    v_cvt_pk_bf16_f32 v70, v60, v61
    v_cvt_pk_bf16_f32 v71, v62, v63
    s_add_u32 s33, s32, 0
    buffer_load_dwordx4 v[140:143], v3, s[8:11], s33 offen offset:3072
    v_mfma_f32_32x32x16_bf16 v[72:87], v[108:111], v[68:71], v[72:87]
    s_mov_b64 exec, s[30:31]
    ds_read_b128 v[104:107], v98 offset:4096
    ds_read_b128 v[108:111], v98 offset:4608
    s_mov_b64 exec, -1
    v_exp_f32 v32, v32
    v_exp_f32 v33, v33
    v_exp_f32 v34, v34
    v_exp_f32 v35, v35
    v_cvt_pk_bf16_f32 v64, v32, v33
    v_cvt_pk_bf16_f32 v65, v34, v35
    s_waitcnt lgkmcnt(2)
    v_mfma_f32_32x32x16_bf16 v[48:63], v[100:103], v[4:7], v[16:31]
    ds_read_b128 v[100:103], v97 offset:6144
    s_cmp_lg_u32 s47, 0
    s_cbranch_scc1 k2_kernel_r1op4
    s_add_u32 s20, s51, 151808
    s_mov_b32 m0, s20
    s_add_u32 s21, s37, s51
    buffer_load_dwordx4 v3, s[4:7], s21 offen lds
    s_min_u32 s20, s51, 5120
    s_add_u32 s21, s20, 135168
    s_add_u32 s20, s20, 145664
    s_mov_b32 m0, s20
    s_nop 0
    buffer_load_dwordx4 v3, s[8:11], s21 offen lds
    s_branch k2_kernel_opdone4
k2_kernel_r1op4:
k2_kernel_opdone4:
    v_exp_f32 v36, v36
    v_exp_f32 v37, v37
    v_exp_f32 v38, v38
    v_exp_f32 v39, v39
    v_cvt_pk_bf16_f32 v66, v36, v37
    v_cvt_pk_bf16_f32 v67, v38, v39
    v_exp_f32 v40, v40
    v_exp_f32 v41, v41
    v_exp_f32 v42, v42
    v_exp_f32 v43, v43
    s_waitcnt lgkmcnt(1)
    v_mfma_f32_32x32x16_bf16 v[72:87], v[104:107], v[64:67], v[72:87]
    v_cvt_pk_bf16_f32 v68, v40, v41
    v_cvt_pk_bf16_f32 v69, v42, v43
    v_exp_f32 v44, v44
    v_exp_f32 v45, v45
    v_exp_f32 v46, v46
    v_exp_f32 v47, v47
    v_cvt_pk_bf16_f32 v70, v44, v45
    v_cvt_pk_bf16_f32 v71, v46, v47
    s_add_u32 s33, s32, 4096
    buffer_load_dwordx4 v[144:147], v3, s[8:11], s33 offen offset:0
    v_mfma_f32_32x32x16_bf16 v[72:87], v[108:111], v[68:71], v[72:87]
    s_mov_b64 exec, s[30:31]
    ds_read_b128 v[104:107], v98 offset:5120
    ds_read_b128 v[108:111], v98 offset:5632
    s_mov_b64 exec, -1
    v_exp_f32 v48, v48
    v_exp_f32 v49, v49
    v_exp_f32 v50, v50
    v_exp_f32 v51, v51
    v_cvt_pk_bf16_f32 v64, v48, v49
    v_cvt_pk_bf16_f32 v65, v50, v51
    s_waitcnt lgkmcnt(2)
    v_mfma_f32_32x32x16_bf16 v[32:47], v[100:103], v[4:7], v[16:31]
    ds_read_b128 v[100:103], v97 offset:7168
    s_cmp_lg_u32 s47, 0
    s_cbranch_scc1 k2_kernel_r1op5
    s_branch k2_kernel_opdone5
k2_kernel_r1op5:
k2_kernel_opdone5:
    v_exp_f32 v52, v52
    v_exp_f32 v53, v53
    v_exp_f32 v54, v54
    v_exp_f32 v55, v55
    v_cvt_pk_bf16_f32 v66, v52, v53
    v_cvt_pk_bf16_f32 v67, v54, v55
    v_exp_f32 v56, v56
    v_exp_f32 v57, v57
    v_exp_f32 v58, v58
    v_exp_f32 v59, v59
    s_waitcnt lgkmcnt(1)
    v_mfma_f32_32x32x16_bf16 v[72:87], v[104:107], v[64:67], v[72:87]
    v_cvt_pk_bf16_f32 v68, v56, v57
    v_cvt_pk_bf16_f32 v69, v58, v59
    v_exp_f32 v60, v60
    v_exp_f32 v61, v61
    v_exp_f32 v62, v62
    v_exp_f32 v63, v63
    v_cvt_pk_bf16_f32 v70, v60, v61
    v_cvt_pk_bf16_f32 v71, v62, v63
    s_add_u32 s33, s32, 4096
    buffer_load_dwordx4 v[148:151], v3, s[8:11], s33 offen offset:1024
    v_mfma_f32_32x32x16_bf16 v[72:87], v[108:111], v[68:71], v[72:87]
    s_mov_b64 exec, s[30:31]
    ds_read_b128 v[104:107], v98 offset:6144
    ds_read_b128 v[108:111], v98 offset:6656
    s_mov_b64 exec, -1
    s_cmp_lg_u32 s47, 0
    s_cbranch_scc1 k2_kernel_nobar
    s_waitcnt vmcnt(2)
    s_barrier
k2_kernel_nobar:
    v_exp_f32 v32, v32
    v_exp_f32 v33, v33
    v_exp_f32 v34, v34
    v_exp_f32 v35, v35
    v_cvt_pk_bf16_f32 v64, v32, v33
    v_cvt_pk_bf16_f32 v65, v34, v35
    s_waitcnt lgkmcnt(2)
    v_mfma_f32_32x32x16_bf16 v[48:63], v[100:103], v[4:7], v[16:31]
    ds_read_b128 v[100:103], v97 offset:8192
    s_cmp_lg_u32 s47, 0
    s_cbranch_scc1 k2_kernel_r1op6
    s_branch k2_kernel_opdone6
k2_kernel_r1op6:
k2_kernel_opdone6:
    v_exp_f32 v36, v36
    v_exp_f32 v37, v37
    v_exp_f32 v38, v38
    v_exp_f32 v39, v39
    v_cvt_pk_bf16_f32 v66, v36, v37
    v_cvt_pk_bf16_f32 v67, v38, v39
    v_exp_f32 v40, v40
    v_exp_f32 v41, v41
    v_exp_f32 v42, v42
    v_exp_f32 v43, v43
    s_waitcnt lgkmcnt(1)
    v_mfma_f32_32x32x16_bf16 v[72:87], v[104:107], v[64:67], v[72:87]
    v_cvt_pk_bf16_f32 v68, v40, v41
    v_cvt_pk_bf16_f32 v69, v42, v43
    v_exp_f32 v44, v44
    v_exp_f32 v45, v45
    v_exp_f32 v46, v46
    v_exp_f32 v47, v47
    v_cvt_pk_bf16_f32 v70, v44, v45
    v_cvt_pk_bf16_f32 v71, v46, v47
    s_add_u32 s33, s32, 4096
    buffer_load_dwordx4 v[152:155], v3, s[8:11], s33 offen offset:2048
    v_mfma_f32_32x32x16_bf16 v[72:87], v[108:111], v[68:71], v[72:87]
    s_mov_b64 exec, s[30:31]
    ds_read_b128 v[104:107], v98 offset:7168
    ds_read_b128 v[108:111], v98 offset:7680
    s_mov_b64 exec, -1
    v_exp_f32 v48, v48
    v_exp_f32 v49, v49
    v_exp_f32 v50, v50
    v_exp_f32 v51, v51
    v_cvt_pk_bf16_f32 v64, v48, v49
    v_cvt_pk_bf16_f32 v65, v50, v51
    s_waitcnt lgkmcnt(2)
    v_mfma_f32_32x32x16_bf16 v[32:47], v[100:103], v[4:7], v[16:31]
    ds_read_b128 v[100:103], v97 offset:9216
    s_cmp_lg_u32 s47, 0
    s_cbranch_scc1 k2_kernel_r1op7
    s_branch k2_kernel_opdone7
k2_kernel_r1op7:
k2_kernel_opdone7:
    v_exp_f32 v52, v52
    v_exp_f32 v53, v53
    v_exp_f32 v54, v54
    v_exp_f32 v55, v55
    v_cvt_pk_bf16_f32 v66, v52, v53
    v_cvt_pk_bf16_f32 v67, v54, v55
    v_exp_f32 v56, v56
    v_exp_f32 v57, v57
    v_exp_f32 v58, v58
    v_exp_f32 v59, v59
    s_waitcnt lgkmcnt(1)
    v_mfma_f32_32x32x16_bf16 v[72:87], v[104:107], v[64:67], v[72:87]
    v_cvt_pk_bf16_f32 v68, v56, v57
    v_cvt_pk_bf16_f32 v69, v58, v59
    v_exp_f32 v60, v60
    v_exp_f32 v61, v61
    v_exp_f32 v62, v62
    v_exp_f32 v63, v63
    v_cvt_pk_bf16_f32 v70, v60, v61
    v_cvt_pk_bf16_f32 v71, v62, v63
    s_add_u32 s33, s32, 4096
    buffer_load_dwordx4 v[156:159], v3, s[8:11], s33 offen offset:3072
    v_mfma_f32_32x32x16_bf16 v[72:87], v[108:111], v[68:71], v[72:87]
    s_mov_b64 exec, s[30:31]
    ds_read_b128 v[104:107], v98 offset:8192
    ds_read_b128 v[108:111], v98 offset:8704
    s_mov_b64 exec, -1
k2_kernel_restart1:
    v_exp_f32 v32, v32
    v_exp_f32 v33, v33
    v_exp_f32 v34, v34
    v_exp_f32 v35, v35
    v_cvt_pk_bf16_f32 v64, v32, v33
    v_cvt_pk_bf16_f32 v65, v34, v35
    s_waitcnt lgkmcnt(2)
    v_mfma_f32_32x32x16_bf16 v[48:63], v[100:103], v[4:7], v[16:31]
    ds_read_b128 v[100:103], v97 offset:10240
    v_exp_f32 v36, v36
    v_exp_f32 v37, v37
    v_exp_f32 v38, v38
    v_exp_f32 v39, v39
    v_cvt_pk_bf16_f32 v66, v36, v37
    v_cvt_pk_bf16_f32 v67, v38, v39
    v_exp_f32 v40, v40
    v_exp_f32 v41, v41
    v_exp_f32 v42, v42
    v_exp_f32 v43, v43
    s_mov_b32 s24, 1
    s_cmp_eq_u32 s25, 1
    s_cbranch_scc1 k2_kernel_ok1
    v_cmp_ngt_f32 vcc, s27, v80
    s_cbranch_vccnz k2_kernel_rollback
k2_kernel_ok1:
    v_cmp_lt_f32 vcc, s28, v80
    s_cbranch_vccnz k2_kernel_renorm
    v_mov_b32 v88, v72
    v_mov_b32 v89, v73
    v_mov_b32 v90, v74
    v_mov_b32 v91, v75
    v_mov_b32 v92, v76
    v_mov_b32 v93, v77
    v_mov_b32 v94, v78
    v_mov_b32 v95, v79
    v_mov_b32 v96, v80
    s_waitcnt lgkmcnt(1)
    v_mfma_f32_32x32x16_bf16 v[72:87], v[104:107], v[64:67], v[72:87]
    v_cvt_pk_bf16_f32 v68, v40, v41
    v_cvt_pk_bf16_f32 v69, v42, v43
    v_exp_f32 v44, v44
    v_exp_f32 v45, v45
    v_exp_f32 v46, v46
    v_exp_f32 v47, v47
    v_cvt_pk_bf16_f32 v70, v44, v45
    v_cvt_pk_bf16_f32 v71, v46, v47
    s_add_u32 s33, s32, 16384
    buffer_load_dwordx4 v[160:163], v3, s[8:11], s33 offen offset:0
    v_mfma_f32_32x32x16_bf16 v[72:87], v[108:111], v[68:71], v[72:87]
    s_mov_b64 exec, s[30:31]
    ds_read_b128 v[104:107], v98 offset:9216
    ds_read_b128 v[108:111], v98 offset:9728
    s_mov_b64 exec, -1
    v_exp_f32 v48, v48
    v_exp_f32 v49, v49
    v_exp_f32 v50, v50
    v_exp_f32 v51, v51
    v_cvt_pk_bf16_f32 v64, v48, v49
    v_cvt_pk_bf16_f32 v65, v50, v51
    s_waitcnt lgkmcnt(2)
    v_mfma_f32_32x32x16_bf16 v[32:47], v[100:103], v[4:7], v[16:31]
    ds_read_b128 v[100:103], v97 offset:11264
    v_exp_f32 v52, v52
    v_exp_f32 v53, v53
    v_exp_f32 v54, v54
    v_exp_f32 v55, v55
    v_cvt_pk_bf16_f32 v66, v52, v53
    v_cvt_pk_bf16_f32 v67, v54, v55
    v_exp_f32 v56, v56
    v_exp_f32 v57, v57
    v_exp_f32 v58, v58
    v_exp_f32 v59, v59
    s_waitcnt lgkmcnt(1)
    v_mfma_f32_32x32x16_bf16 v[72:87], v[104:107], v[64:67], v[72:87]
    v_cvt_pk_bf16_f32 v68, v56, v57
    v_cvt_pk_bf16_f32 v69, v58, v59
    v_exp_f32 v60, v60
    v_exp_f32 v61, v61
    v_exp_f32 v62, v62
    v_exp_f32 v63, v63
    v_cvt_pk_bf16_f32 v70, v60, v61
    v_cvt_pk_bf16_f32 v71, v62, v63
    s_add_u32 s33, s32, 16384
    buffer_load_dwordx4 v[164:167], v3, s[8:11], s33 offen offset:1024
    v_mfma_f32_32x32x16_bf16 v[72:87], v[108:111], v[68:71], v[72:87]
    s_mov_b64 exec, s[30:31]
    ds_read_b128 v[104:107], v98 offset:10240
    ds_read_b128 v[108:111], v98 offset:10752
    s_mov_b64 exec, -1
    v_exp_f32 v32, v32
    v_exp_f32 v33, v33
    v_exp_f32 v34, v34
    v_exp_f32 v35, v35
    v_cvt_pk_bf16_f32 v64, v32, v33
    v_cvt_pk_bf16_f32 v65, v34, v35
    s_waitcnt lgkmcnt(2)
    v_mfma_f32_32x32x16_bf16 v[48:63], v[100:103], v[4:7], v[16:31]
    ds_read_b128 v[100:103], v97 offset:12288
    v_exp_f32 v36, v36
    v_exp_f32 v37, v37
    v_exp_f32 v38, v38
    v_exp_f32 v39, v39
    v_cvt_pk_bf16_f32 v66, v36, v37
    v_cvt_pk_bf16_f32 v67, v38, v39
    v_exp_f32 v40, v40
    v_exp_f32 v41, v41
    v_exp_f32 v42, v42
    v_exp_f32 v43, v43
    s_waitcnt lgkmcnt(1)
    v_mfma_f32_32x32x16_bf16 v[72:87], v[104:107], v[64:67], v[72:87]
    v_cvt_pk_bf16_f32 v68, v40, v41
    v_cvt_pk_bf16_f32 v69, v42, v43
    v_exp_f32 v44, v44
    v_exp_f32 v45, v45
    v_exp_f32 v46, v46
    v_exp_f32 v47, v47
    v_cvt_pk_bf16_f32 v70, v44, v45
    v_cvt_pk_bf16_f32 v71, v46, v47
    s_add_u32 s33, s32, 16384
    buffer_load_dwordx4 v[168:171], v3, s[8:11], s33 offen offset:2048
    v_mfma_f32_32x32x16_bf16 v[72:87], v[108:111], v[68:71], v[72:87]
    s_mov_b64 exec, s[30:31]
    ds_read_b128 v[104:107], v98 offset:11264
    ds_read_b128 v[108:111], v98 offset:11776
    s_mov_b64 exec, -1
    v_exp_f32 v48, v48
    v_exp_f32 v49, v49
    v_exp_f32 v50, v50
    v_exp_f32 v51, v51
    v_cvt_pk_bf16_f32 v64, v48, v49
    v_cvt_pk_bf16_f32 v65, v50, v51
    s_waitcnt lgkmcnt(2)
    v_mfma_f32_32x32x16_bf16 v[32:47], v[100:103], v[4:7], v[16:31]
    ds_read_b128 v[100:103], v97 offset:13312
    v_exp_f32 v52, v52
    v_exp_f32 v53, v53
    v_exp_f32 v54, v54
    v_exp_f32 v55, v55
    v_cvt_pk_bf16_f32 v66, v52, v53
    v_cvt_pk_bf16_f32 v67, v54, v55
    v_exp_f32 v56, v56
    v_exp_f32 v57, v57
    v_exp_f32 v58, v58
    v_exp_f32 v59, v59
    s_waitcnt lgkmcnt(1)
    v_mfma_f32_32x32x16_bf16 v[72:87], v[104:107], v[64:67], v[72:87]
    v_cvt_pk_bf16_f32 v68, v56, v57
    v_cvt_pk_bf16_f32 v69, v58, v59
    v_exp_f32 v60, v60
    v_exp_f32 v61, v61
    v_exp_f32 v62, v62
    v_exp_f32 v63, v63
    v_cvt_pk_bf16_f32 v70, v60, v61
    v_cvt_pk_bf16_f32 v71, v62, v63
    s_add_u32 s33, s32, 16384
    buffer_load_dwordx4 v[172:175], v3, s[8:11], s33 offen offset:3072
    v_mfma_f32_32x32x16_bf16 v[72:87], v[108:111], v[68:71], v[72:87]
    s_mov_b64 exec, s[30:31]
    ds_read_b128 v[104:107], v98 offset:12288
    ds_read_b128 v[108:111], v98 offset:12800
    s_mov_b64 exec, -1
    v_exp_f32 v32, v32
    v_exp_f32 v33, v33
    v_exp_f32 v34, v34
    v_exp_f32 v35, v35
    v_cvt_pk_bf16_f32 v64, v32, v33
    v_cvt_pk_bf16_f32 v65, v34, v35
    s_waitcnt lgkmcnt(2)
    v_mfma_f32_32x32x16_bf16 v[48:63], v[100:103], v[4:7], v[16:31]
    ds_read_b128 v[100:103], v97 offset:14336
    v_exp_f32 v36, v36
    v_exp_f32 v37, v37
    v_exp_f32 v38, v38
    v_exp_f32 v39, v39
    v_cvt_pk_bf16_f32 v66, v36, v37
    v_cvt_pk_bf16_f32 v67, v38, v39
    v_exp_f32 v40, v40
    v_exp_f32 v41, v41
    v_exp_f32 v42, v42
    v_exp_f32 v43, v43
    s_waitcnt lgkmcnt(1)
    v_mfma_f32_32x32x16_bf16 v[72:87], v[104:107], v[64:67], v[72:87]
    v_cvt_pk_bf16_f32 v68, v40, v41
    v_cvt_pk_bf16_f32 v69, v42, v43
    v_exp_f32 v44, v44
    v_exp_f32 v45, v45
    v_exp_f32 v46, v46
    v_exp_f32 v47, v47
    v_cvt_pk_bf16_f32 v70, v44, v45
    v_cvt_pk_bf16_f32 v71, v46, v47
    s_add_u32 s33, s32, 20480
    buffer_load_dwordx4 v[176:179], v3, s[8:11], s33 offen offset:0
    v_mfma_f32_32x32x16_bf16 v[72:87], v[108:111], v[68:71], v[72:87]
    s_mov_b64 exec, s[30:31]
    ds_read_b128 v[104:107], v98 offset:13312
    ds_read_b128 v[108:111], v98 offset:13824
    s_mov_b64 exec, -1
    v_exp_f32 v48, v48
    v_exp_f32 v49, v49
    v_exp_f32 v50, v50
    v_exp_f32 v51, v51
    v_cvt_pk_bf16_f32 v64, v48, v49
    v_cvt_pk_bf16_f32 v65, v50, v51
    s_waitcnt lgkmcnt(2)
    v_mfma_f32_32x32x16_bf16 v[32:47], v[100:103], v[4:7], v[16:31]
    ds_read_b128 v[100:103], v97 offset:15360
    v_exp_f32 v52, v52
    v_exp_f32 v53, v53
    v_exp_f32 v54, v54
    v_exp_f32 v55, v55
    v_cvt_pk_bf16_f32 v66, v52, v53
    v_cvt_pk_bf16_f32 v67, v54, v55
    v_exp_f32 v56, v56
    v_exp_f32 v57, v57
    v_exp_f32 v58, v58
    v_exp_f32 v59, v59
    s_waitcnt lgkmcnt(1)
    v_mfma_f32_32x32x16_bf16 v[72:87], v[104:107], v[64:67], v[72:87]
    v_cvt_pk_bf16_f32 v68, v56, v57
    v_cvt_pk_bf16_f32 v69, v58, v59
    v_exp_f32 v60, v60
    v_exp_f32 v61, v61
    v_exp_f32 v62, v62
    v_exp_f32 v63, v63
    v_cvt_pk_bf16_f32 v70, v60, v61
    v_cvt_pk_bf16_f32 v71, v62, v63
    s_add_u32 s33, s32, 20480
    buffer_load_dwordx4 v[180:183], v3, s[8:11], s33 offen offset:1024
    v_mfma_f32_32x32x16_bf16 v[72:87], v[108:111], v[68:71], v[72:87]
    s_mov_b64 exec, s[30:31]
    ds_read_b128 v[104:107], v98 offset:14336
    ds_read_b128 v[108:111], v98 offset:14848
    s_mov_b64 exec, -1
    v_exp_f32 v32, v32
    v_exp_f32 v33, v33
    v_exp_f32 v34, v34
    v_exp_f32 v35, v35
    v_cvt_pk_bf16_f32 v64, v32, v33
    v_cvt_pk_bf16_f32 v65, v34, v35
    s_waitcnt lgkmcnt(2)
    v_mfma_f32_32x32x16_bf16 v[48:63], v[100:103], v[4:7], v[16:31]
    ds_read_b128 v[100:103], v97 offset:16384
    v_exp_f32 v36, v36
    v_exp_f32 v37, v37
    v_exp_f32 v38, v38
    v_exp_f32 v39, v39
    v_cvt_pk_bf16_f32 v66, v36, v37
    v_cvt_pk_bf16_f32 v67, v38, v39
    v_exp_f32 v40, v40
    v_exp_f32 v41, v41
    v_exp_f32 v42, v42
    v_exp_f32 v43, v43
    s_waitcnt lgkmcnt(1)
    v_mfma_f32_32x32x16_bf16 v[72:87], v[104:107], v[64:67], v[72:87]
    v_cvt_pk_bf16_f32 v68, v40, v41
    v_cvt_pk_bf16_f32 v69, v42, v43
    v_exp_f32 v44, v44
    v_exp_f32 v45, v45
    v_exp_f32 v46, v46
    v_exp_f32 v47, v47
    v_cvt_pk_bf16_f32 v70, v44, v45
    v_cvt_pk_bf16_f32 v71, v46, v47
    s_add_u32 s33, s32, 20480
    buffer_load_dwordx4 v[184:187], v3, s[8:11], s33 offen offset:2048
    v_mfma_f32_32x32x16_bf16 v[72:87], v[108:111], v[68:71], v[72:87]
    s_mov_b64 exec, s[30:31]
    ds_read_b128 v[104:107], v98 offset:15360
    ds_read_b128 v[108:111], v98 offset:15872
    s_mov_b64 exec, -1
    v_exp_f32 v48, v48
    v_exp_f32 v49, v49
    v_exp_f32 v50, v50
    v_exp_f32 v51, v51
    v_cvt_pk_bf16_f32 v64, v48, v49
    v_cvt_pk_bf16_f32 v65, v50, v51
    s_waitcnt lgkmcnt(2)
    v_mfma_f32_32x32x16_bf16 v[32:47], v[100:103], v[4:7], v[16:31]
    ds_read_b128 v[100:103], v97 offset:17408
    v_exp_f32 v52, v52
    v_exp_f32 v53, v53
    v_exp_f32 v54, v54
    v_exp_f32 v55, v55
    v_cvt_pk_bf16_f32 v66, v52, v53
    v_cvt_pk_bf16_f32 v67, v54, v55
    v_exp_f32 v56, v56
    v_exp_f32 v57, v57
    v_exp_f32 v58, v58
    v_exp_f32 v59, v59
    s_waitcnt lgkmcnt(1)
    v_mfma_f32_32x32x16_bf16 v[72:87], v[104:107], v[64:67], v[72:87]
    v_cvt_pk_bf16_f32 v68, v56, v57
    v_cvt_pk_bf16_f32 v69, v58, v59
    v_exp_f32 v60, v60
    v_exp_f32 v61, v61
    v_exp_f32 v62, v62
    v_exp_f32 v63, v63
    v_cvt_pk_bf16_f32 v70, v60, v61
    v_cvt_pk_bf16_f32 v71, v62, v63
    s_add_u32 s33, s32, 20480
    buffer_load_dwordx4 v[188:191], v3, s[8:11], s33 offen offset:3072
    v_mfma_f32_32x32x16_bf16 v[72:87], v[108:111], v[68:71], v[72:87]
    s_mov_b64 exec, s[30:31]
    ds_read_b128 v[104:107], v98 offset:16384
    ds_read_b128 v[108:111], v98 offset:16896
    s_mov_b64 exec, -1
k2_kernel_restart2:
    v_exp_f32 v32, v32
    v_exp_f32 v33, v33
    v_exp_f32 v34, v34
    v_exp_f32 v35, v35
    v_cvt_pk_bf16_f32 v64, v32, v33
    v_cvt_pk_bf16_f32 v65, v34, v35
    s_waitcnt lgkmcnt(2)
    v_mfma_f32_32x32x16_bf16 v[48:63], v[100:103], v[4:7], v[16:31]
    ds_read_b128 v[100:103], v97 offset:18432
    v_exp_f32 v36, v36
    v_exp_f32 v37, v37
    v_exp_f32 v38, v38
    v_exp_f32 v39, v39
    v_cvt_pk_bf16_f32 v66, v36, v37
    v_cvt_pk_bf16_f32 v67, v38, v39
    v_exp_f32 v40, v40
    v_exp_f32 v41, v41
    v_exp_f32 v42, v42
    v_exp_f32 v43, v43
    s_mov_b32 s24, 2
    s_cmp_eq_u32 s25, 2
    s_cbranch_scc1 k2_kernel_ok2
    v_cmp_ngt_f32 vcc, s27, v80
    s_cbranch_vccnz k2_kernel_rollback
k2_kernel_ok2:
    v_cmp_lt_f32 vcc, s28, v80
    s_cbranch_vccnz k2_kernel_renorm
    v_mov_b32 v88, v72
    v_mov_b32 v89, v73
    v_mov_b32 v90, v74
    v_mov_b32 v91, v75
    v_mov_b32 v92, v76
    v_mov_b32 v93, v77
    v_mov_b32 v94, v78
    v_mov_b32 v95, v79
    v_mov_b32 v96, v80
    s_waitcnt lgkmcnt(1)
    v_mfma_f32_32x32x16_bf16 v[72:87], v[104:107], v[64:67], v[72:87]
    v_cvt_pk_bf16_f32 v68, v40, v41
    v_cvt_pk_bf16_f32 v69, v42, v43
    v_exp_f32 v44, v44
    v_exp_f32 v45, v45
    v_exp_f32 v46, v46
    v_exp_f32 v47, v47
    v_cvt_pk_bf16_f32 v70, v44, v45
    v_cvt_pk_bf16_f32 v71, v46, v47
    s_add_u32 s33, s32, 32768
    buffer_load_dwordx4 v[192:195], v3, s[8:11], s33 offen offset:0
    v_mfma_f32_32x32x16_bf16 v[72:87], v[108:111], v[68:71], v[72:87]
    s_mov_b64 exec, s[30:31]
    ds_read_b128 v[104:107], v98 offset:17408
    ds_read_b128 v[108:111], v98 offset:17920
    s_mov_b64 exec, -1
    v_exp_f32 v48, v48
    v_exp_f32 v49, v49
    v_exp_f32 v50, v50
    v_exp_f32 v51, v51
    v_cvt_pk_bf16_f32 v64, v48, v49
    v_cvt_pk_bf16_f32 v65, v50, v51
    s_waitcnt lgkmcnt(2)
    v_mfma_f32_32x32x16_bf16 v[32:47], v[100:103], v[4:7], v[16:31]
    ds_read_b128 v[100:103], v97 offset:19456
    v_exp_f32 v52, v52
    v_exp_f32 v53, v53
    v_exp_f32 v54, v54
    v_exp_f32 v55, v55
    v_cvt_pk_bf16_f32 v66, v52, v53
    v_cvt_pk_bf16_f32 v67, v54, v55
    v_exp_f32 v56, v56
    v_exp_f32 v57, v57
    v_exp_f32 v58, v58
    v_exp_f32 v59, v59
    s_waitcnt lgkmcnt(1)
    v_mfma_f32_32x32x16_bf16 v[72:87], v[104:107], v[64:67], v[72:87]
    v_cvt_pk_bf16_f32 v68, v56, v57
    v_cvt_pk_bf16_f32 v69, v58, v59
    v_exp_f32 v60, v60
    v_exp_f32 v61, v61
    v_exp_f32 v62, v62
    v_exp_f32 v63, v63
    v_cvt_pk_bf16_f32 v70, v60, v61
    v_cvt_pk_bf16_f32 v71, v62, v63
    s_add_u32 s33, s32, 32768
    buffer_load_dwordx4 v[196:199], v3, s[8:11], s33 offen offset:1024
    v_mfma_f32_32x32x16_bf16 v[72:87], v[108:111], v[68:71], v[72:87]
    s_mov_b64 exec, s[30:31]
    ds_read_b128 v[104:107], v98 offset:18432
    ds_read_b128 v[108:111], v98 offset:18944
    s_mov_b64 exec, -1
    v_exp_f32 v32, v32
    v_exp_f32 v33, v33
    v_exp_f32 v34, v34
    v_exp_f32 v35, v35
    v_cvt_pk_bf16_f32 v64, v32, v33
    v_cvt_pk_bf16_f32 v65, v34, v35
    s_waitcnt lgkmcnt(2)
    v_mfma_f32_32x32x16_bf16 v[48:63], v[100:103], v[4:7], v[16:31]
    ds_read_b128 v[100:103], v97 offset:20480
    v_exp_f32 v36, v36
    v_exp_f32 v37, v37
    v_exp_f32 v38, v38
    v_exp_f32 v39, v39
    v_cvt_pk_bf16_f32 v66, v36, v37
    v_cvt_pk_bf16_f32 v67, v38, v39
    v_exp_f32 v40, v40
    v_exp_f32 v41, v41
    v_exp_f32 v42, v42
    v_exp_f32 v43, v43
    s_waitcnt lgkmcnt(1)
    v_mfma_f32_32x32x16_bf16 v[72:87], v[104:107], v[64:67], v[72:87]
    v_cvt_pk_bf16_f32 v68, v40, v41
    v_cvt_pk_bf16_f32 v69, v42, v43
    v_exp_f32 v44, v44
    v_exp_f32 v45, v45
    v_exp_f32 v46, v46
    v_exp_f32 v47, v47
    v_cvt_pk_bf16_f32 v70, v44, v45
    v_cvt_pk_bf16_f32 v71, v46, v47
    s_add_u32 s33, s32, 32768
    buffer_load_dwordx4 v[200:203], v3, s[8:11], s33 offen offset:2048
    v_mfma_f32_32x32x16_bf16 v[72:87], v[108:111], v[68:71], v[72:87]
    s_mov_b64 exec, s[30:31]
    ds_read_b128 v[104:107], v98 offset:19456
    ds_read_b128 v[108:111], v98 offset:19968
    s_mov_b64 exec, -1
    v_exp_f32 v48, v48
    v_exp_f32 v49, v49
    v_exp_f32 v50, v50
    v_exp_f32 v51, v51
    v_cvt_pk_bf16_f32 v64, v48, v49
    v_cvt_pk_bf16_f32 v65, v50, v51
    s_waitcnt lgkmcnt(2)
    v_mfma_f32_32x32x16_bf16 v[32:47], v[100:103], v[4:7], v[16:31]
    ds_read_b128 v[100:103], v97 offset:21504
    v_exp_f32 v52, v52
    v_exp_f32 v53, v53
    v_exp_f32 v54, v54
    v_exp_f32 v55, v55
    v_cvt_pk_bf16_f32 v66, v52, v53
    v_cvt_pk_bf16_f32 v67, v54, v55
    v_exp_f32 v56, v56
    v_exp_f32 v57, v57
    v_exp_f32 v58, v58
    v_exp_f32 v59, v59
    s_waitcnt lgkmcnt(1)
    v_mfma_f32_32x32x16_bf16 v[72:87], v[104:107], v[64:67], v[72:87]
    v_cvt_pk_bf16_f32 v68, v56, v57
    v_cvt_pk_bf16_f32 v69, v58, v59
    v_exp_f32 v60, v60
    v_exp_f32 v61, v61
    v_exp_f32 v62, v62
    v_exp_f32 v63, v63
    v_cvt_pk_bf16_f32 v70, v60, v61
    v_cvt_pk_bf16_f32 v71, v62, v63
    s_add_u32 s33, s32, 32768
    buffer_load_dwordx4 v[204:207], v3, s[8:11], s33 offen offset:3072
    v_mfma_f32_32x32x16_bf16 v[72:87], v[108:111], v[68:71], v[72:87]
    s_mov_b64 exec, s[30:31]
    ds_read_b128 v[104:107], v98 offset:20480
    ds_read_b128 v[108:111], v98 offset:20992
    s_mov_b64 exec, -1
    v_exp_f32 v32, v32
    v_exp_f32 v33, v33
    v_exp_f32 v34, v34
    v_exp_f32 v35, v35
    v_cvt_pk_bf16_f32 v64, v32, v33
    v_cvt_pk_bf16_f32 v65, v34, v35
    s_waitcnt lgkmcnt(2)
    v_mfma_f32_32x32x16_bf16 v[48:63], v[100:103], v[4:7], v[16:31]
    ds_read_b128 v[100:103], v97 offset:22528
    v_exp_f32 v36, v36
    v_exp_f32 v37, v37
    v_exp_f32 v38, v38
    v_exp_f32 v39, v39
    v_cvt_pk_bf16_f32 v66, v36, v37
    v_cvt_pk_bf16_f32 v67, v38, v39
    v_exp_f32 v40, v40
    v_exp_f32 v41, v41
    v_exp_f32 v42, v42
    v_exp_f32 v43, v43
    s_waitcnt lgkmcnt(1)
    v_mfma_f32_32x32x16_bf16 v[72:87], v[104:107], v[64:67], v[72:87]
    v_cvt_pk_bf16_f32 v68, v40, v41
    v_cvt_pk_bf16_f32 v69, v42, v43
    v_exp_f32 v44, v44
    v_exp_f32 v45, v45
    v_exp_f32 v46, v46
    v_exp_f32 v47, v47
    v_cvt_pk_bf16_f32 v70, v44, v45
    v_cvt_pk_bf16_f32 v71, v46, v47
    s_add_u32 s33, s32, 36864
    buffer_load_dwordx4 v[208:211], v3, s[8:11], s33 offen offset:0
    v_mfma_f32_32x32x16_bf16 v[72:87], v[108:111], v[68:71], v[72:87]
    s_mov_b64 exec, s[30:31]
    ds_read_b128 v[104:107], v98 offset:21504
    ds_read_b128 v[108:111], v98 offset:22016
    s_mov_b64 exec, -1
    v_exp_f32 v48, v48
    v_exp_f32 v49, v49
    v_exp_f32 v50, v50
    v_exp_f32 v51, v51
    v_cvt_pk_bf16_f32 v64, v48, v49
    v_cvt_pk_bf16_f32 v65, v50, v51
    s_waitcnt lgkmcnt(2)
    v_mfma_f32_32x32x16_bf16 v[32:47], v[100:103], v[4:7], v[16:31]
    ds_read_b128 v[100:103], v97 offset:23552
    v_exp_f32 v52, v52
    v_exp_f32 v53, v53
    v_exp_f32 v54, v54
    v_exp_f32 v55, v55
    v_cvt_pk_bf16_f32 v66, v52, v53
    v_cvt_pk_bf16_f32 v67, v54, v55
    v_exp_f32 v56, v56
    v_exp_f32 v57, v57
    v_exp_f32 v58, v58
    v_exp_f32 v59, v59
    s_waitcnt lgkmcnt(1)
    v_mfma_f32_32x32x16_bf16 v[72:87], v[104:107], v[64:67], v[72:87]
    v_cvt_pk_bf16_f32 v68, v56, v57
    v_cvt_pk_bf16_f32 v69, v58, v59
    v_exp_f32 v60, v60
    v_exp_f32 v61, v61
    v_exp_f32 v62, v62
    v_exp_f32 v63, v63
    v_cvt_pk_bf16_f32 v70, v60, v61
    v_cvt_pk_bf16_f32 v71, v62, v63
    s_add_u32 s33, s32, 36864
    buffer_load_dwordx4 v[212:215], v3, s[8:11], s33 offen offset:1024
    v_mfma_f32_32x32x16_bf16 v[72:87], v[108:111], v[68:71], v[72:87]
    s_mov_b64 exec, s[30:31]
    ds_read_b128 v[104:107], v98 offset:22528
    ds_read_b128 v[108:111], v98 offset:23040
    s_mov_b64 exec, -1
    s_setprio 0
    v_exp_f32 v32, v32
    v_exp_f32 v33, v33
    v_exp_f32 v34, v34
    v_exp_f32 v35, v35
    v_cvt_pk_bf16_f32 v64, v32, v33
    v_cvt_pk_bf16_f32 v65, v34, v35
    s_waitcnt lgkmcnt(2)
    v_mfma_f32_32x32x16_bf16 v[48:63], v[100:103], v[4:7], v[16:31]
    ds_read_b128 v[100:103], v97 offset:24576
    v_exp_f32 v36, v36
    v_exp_f32 v37, v37
    v_exp_f32 v38, v38
    v_exp_f32 v39, v39
    v_cvt_pk_bf16_f32 v66, v36, v37
    v_cvt_pk_bf16_f32 v67, v38, v39
    v_exp_f32 v40, v40
    v_exp_f32 v41, v41
    v_exp_f32 v42, v42
    v_exp_f32 v43, v43
    s_waitcnt lgkmcnt(1)
    v_mfma_f32_32x32x16_bf16 v[72:87], v[104:107], v[64:67], v[72:87]
    v_cvt_pk_bf16_f32 v68, v40, v41
    v_cvt_pk_bf16_f32 v69, v42, v43
    v_exp_f32 v44, v44
    v_exp_f32 v45, v45
    v_exp_f32 v46, v46
    v_exp_f32 v47, v47
    v_cvt_pk_bf16_f32 v70, v44, v45
    v_cvt_pk_bf16_f32 v71, v46, v47
    s_add_u32 s33, s32, 36864
    buffer_load_dwordx4 v[216:219], v3, s[8:11], s33 offen offset:2048
    v_mfma_f32_32x32x16_bf16 v[72:87], v[108:111], v[68:71], v[72:87]
    s_mov_b64 exec, s[30:31]
    ds_read_b128 v[104:107], v98 offset:23552
    ds_read_b128 v[108:111], v98 offset:24064
    s_mov_b64 exec, -1
    v_exp_f32 v48, v48
    v_exp_f32 v49, v49
    v_exp_f32 v50, v50
    v_exp_f32 v51, v51
    v_cvt_pk_bf16_f32 v64, v48, v49
    v_cvt_pk_bf16_f32 v65, v50, v51
    s_waitcnt lgkmcnt(2)
    v_mfma_f32_32x32x16_bf16 v[32:47], v[100:103], v[4:7], v[16:31]
    ds_read_b128 v[100:103], v97 offset:25600
    v_exp_f32 v52, v52
    v_exp_f32 v53, v53
    v_exp_f32 v54, v54
    v_exp_f32 v55, v55
    v_cvt_pk_bf16_f32 v66, v52, v53
    v_cvt_pk_bf16_f32 v67, v54, v55
    v_exp_f32 v56, v56
    v_exp_f32 v57, v57
    v_exp_f32 v58, v58
    v_exp_f32 v59, v59
    s_waitcnt lgkmcnt(1)
    v_mfma_f32_32x32x16_bf16 v[72:87], v[104:107], v[64:67], v[72:87]
    v_cvt_pk_bf16_f32 v68, v56, v57
    v_cvt_pk_bf16_f32 v69, v58, v59
    v_exp_f32 v60, v60
    v_exp_f32 v61, v61
    v_exp_f32 v62, v62
    v_exp_f32 v63, v63
    v_cvt_pk_bf16_f32 v70, v60, v61
    v_cvt_pk_bf16_f32 v71, v62, v63
    s_add_u32 s33, s32, 36864
    buffer_load_dwordx4 v[220:223], v3, s[8:11], s33 offen offset:3072
    v_mfma_f32_32x32x16_bf16 v[72:87], v[108:111], v[68:71], v[72:87]
    s_mov_b64 exec, s[30:31]
    ds_read_b128 v[104:107], v98 offset:24576
    ds_read_b128 v[108:111], v98 offset:25088
    s_mov_b64 exec, -1
k2_kernel_restart3:
    v_exp_f32 v32, v32
    v_exp_f32 v33, v33
    v_exp_f32 v34, v34
    v_exp_f32 v35, v35
    v_cvt_pk_bf16_f32 v64, v32, v33
    v_cvt_pk_bf16_f32 v65, v34, v35
    s_waitcnt lgkmcnt(2)
    v_mfma_f32_32x32x16_bf16 v[48:63], v[100:103], v[4:7], v[16:31]
    ds_read_b128 v[100:103], v97 offset:26624
    v_exp_f32 v36, v36
    v_exp_f32 v37, v37
    v_exp_f32 v38, v38
    v_exp_f32 v39, v39
    v_cvt_pk_bf16_f32 v66, v36, v37
    v_cvt_pk_bf16_f32 v67, v38, v39
    v_exp_f32 v40, v40
    v_exp_f32 v41, v41
    v_exp_f32 v42, v42
    v_exp_f32 v43, v43
    s_mov_b32 s24, 3
    s_cmp_eq_u32 s25, 3
    s_cbranch_scc1 k2_kernel_ok3
    v_cmp_ngt_f32 vcc, s27, v80
    s_cbranch_vccnz k2_kernel_rollback
k2_kernel_ok3:
    v_cmp_lt_f32 vcc, s28, v80
    s_cbranch_vccnz k2_kernel_renorm
    v_mov_b32 v88, v72
    v_mov_b32 v89, v73
    v_mov_b32 v90, v74
    v_mov_b32 v91, v75
    v_mov_b32 v92, v76
    v_mov_b32 v93, v77
    v_mov_b32 v94, v78
    v_mov_b32 v95, v79
    v_mov_b32 v96, v80
    s_waitcnt lgkmcnt(1)
    v_mfma_f32_32x32x16_bf16 v[72:87], v[104:107], v[64:67], v[72:87]
    v_cvt_pk_bf16_f32 v68, v40, v41
    v_cvt_pk_bf16_f32 v69, v42, v43
    v_exp_f32 v44, v44
    v_exp_f32 v45, v45
    v_exp_f32 v46, v46
    v_exp_f32 v47, v47
    v_cvt_pk_bf16_f32 v70, v44, v45
    v_cvt_pk_bf16_f32 v71, v46, v47
    s_add_u32 s33, s32, 49152
    buffer_load_dwordx4 v[224:227], v3, s[8:11], s33 offen offset:0
    v_mfma_f32_32x32x16_bf16 v[72:87], v[108:111], v[68:71], v[72:87]
    s_mov_b64 exec, s[30:31]
    ds_read_b128 v[104:107], v98 offset:25600
    ds_read_b128 v[108:111], v98 offset:26112
    s_mov_b64 exec, -1
    v_exp_f32 v48, v48
    v_exp_f32 v49, v49
    v_exp_f32 v50, v50
    v_exp_f32 v51, v51
    v_cvt_pk_bf16_f32 v64, v48, v49
    v_cvt_pk_bf16_f32 v65, v50, v51
    s_waitcnt lgkmcnt(2)
    v_mfma_f32_32x32x16_bf16 v[32:47], v[100:103], v[4:7], v[16:31]
    ds_read_b128 v[100:103], v97 offset:27648
    v_exp_f32 v52, v52
    v_exp_f32 v53, v53
    v_exp_f32 v54, v54
    v_exp_f32 v55, v55
    v_cvt_pk_bf16_f32 v66, v52, v53
    v_cvt_pk_bf16_f32 v67, v54, v55
    v_exp_f32 v56, v56
    v_exp_f32 v57, v57
    v_exp_f32 v58, v58
    v_exp_f32 v59, v59
    s_waitcnt lgkmcnt(1)
    v_mfma_f32_32x32x16_bf16 v[72:87], v[104:107], v[64:67], v[72:87]
    v_cvt_pk_bf16_f32 v68, v56, v57
    v_cvt_pk_bf16_f32 v69, v58, v59
    v_exp_f32 v60, v60
    v_exp_f32 v61, v61
    v_exp_f32 v62, v62
    v_exp_f32 v63, v63
    v_cvt_pk_bf16_f32 v70, v60, v61
    v_cvt_pk_bf16_f32 v71, v62, v63
    s_add_u32 s33, s32, 49152
    buffer_load_dwordx4 v[228:231], v3, s[8:11], s33 offen offset:1024
    v_mfma_f32_32x32x16_bf16 v[72:87], v[108:111], v[68:71], v[72:87]
    s_mov_b64 exec, s[30:31]
    ds_read_b128 v[104:107], v98 offset:26624
    ds_read_b128 v[108:111], v98 offset:27136
    s_mov_b64 exec, -1
    v_exp_f32 v32, v32
    v_exp_f32 v33, v33
    v_exp_f32 v34, v34
    v_exp_f32 v35, v35
    v_cvt_pk_bf16_f32 v64, v32, v33
    v_cvt_pk_bf16_f32 v65, v34, v35
    s_waitcnt lgkmcnt(2)
    v_mfma_f32_32x32x16_bf16 v[48:63], v[100:103], v[4:7], v[16:31]
    ds_read_b128 v[100:103], v97 offset:28672
    v_exp_f32 v36, v36
    v_exp_f32 v37, v37
    v_exp_f32 v38, v38
    v_exp_f32 v39, v39
    v_cvt_pk_bf16_f32 v66, v36, v37
    v_cvt_pk_bf16_f32 v67, v38, v39
    v_exp_f32 v40, v40
    v_exp_f32 v41, v41
    v_exp_f32 v42, v42
    v_exp_f32 v43, v43
    s_waitcnt lgkmcnt(1)
    v_mfma_f32_32x32x16_bf16 v[72:87], v[104:107], v[64:67], v[72:87]
    v_cvt_pk_bf16_f32 v68, v40, v41
    v_cvt_pk_bf16_f32 v69, v42, v43
    v_exp_f32 v44, v44
    v_exp_f32 v45, v45
    v_exp_f32 v46, v46
    v_exp_f32 v47, v47
    v_cvt_pk_bf16_f32 v70, v44, v45
    v_cvt_pk_bf16_f32 v71, v46, v47
    s_add_u32 s33, s32, 49152
    buffer_load_dwordx4 v[232:235], v3, s[8:11], s33 offen offset:2048
    v_mfma_f32_32x32x16_bf16 v[72:87], v[108:111], v[68:71], v[72:87]
    s_mov_b64 exec, s[30:31]
    ds_read_b128 v[104:107], v98 offset:27648
    ds_read_b128 v[108:111], v98 offset:28160
    s_mov_b64 exec, -1
    v_exp_f32 v48, v48
    v_exp_f32 v49, v49
    v_exp_f32 v50, v50
    v_exp_f32 v51, v51
    v_cvt_pk_bf16_f32 v64, v48, v49
    v_cvt_pk_bf16_f32 v65, v50, v51
    s_waitcnt lgkmcnt(2)
    v_mfma_f32_32x32x16_bf16 v[32:47], v[100:103], v[4:7], v[16:31]
    ds_read_b128 v[100:103], v97 offset:29696
    v_exp_f32 v52, v52
    v_exp_f32 v53, v53
    v_exp_f32 v54, v54
    v_exp_f32 v55, v55
    v_cvt_pk_bf16_f32 v66, v52, v53
    v_cvt_pk_bf16_f32 v67, v54, v55
    v_exp_f32 v56, v56
    v_exp_f32 v57, v57
    v_exp_f32 v58, v58
    v_exp_f32 v59, v59
    s_waitcnt lgkmcnt(1)
    v_mfma_f32_32x32x16_bf16 v[72:87], v[104:107], v[64:67], v[72:87]
    v_cvt_pk_bf16_f32 v68, v56, v57
    v_cvt_pk_bf16_f32 v69, v58, v59
    v_exp_f32 v60, v60
    v_exp_f32 v61, v61
    v_exp_f32 v62, v62
    v_exp_f32 v63, v63
    v_cvt_pk_bf16_f32 v70, v60, v61
    v_cvt_pk_bf16_f32 v71, v62, v63
    s_add_u32 s33, s32, 49152
    buffer_load_dwordx4 v[236:239], v3, s[8:11], s33 offen offset:3072
    v_mfma_f32_32x32x16_bf16 v[72:87], v[108:111], v[68:71], v[72:87]
    s_mov_b64 exec, s[30:31]
    ds_read_b128 v[104:107], v98 offset:28672
    ds_read_b128 v[108:111], v98 offset:29184
    s_mov_b64 exec, -1
    v_exp_f32 v32, v32
    v_exp_f32 v33, v33
    v_exp_f32 v34, v34
    v_exp_f32 v35, v35
    v_cvt_pk_bf16_f32 v64, v32, v33
    v_cvt_pk_bf16_f32 v65, v34, v35
    s_waitcnt lgkmcnt(2)
    v_mfma_f32_32x32x16_bf16 v[48:63], v[100:103], v[4:7], v[16:31]
    ds_read_b128 v[100:103], v97 offset:30720
    v_exp_f32 v36, v36
    v_exp_f32 v37, v37
    v_exp_f32 v38, v38
    v_exp_f32 v39, v39
    v_cvt_pk_bf16_f32 v66, v36, v37
    v_cvt_pk_bf16_f32 v67, v38, v39
    v_exp_f32 v40, v40
    v_exp_f32 v41, v41
    v_exp_f32 v42, v42
    v_exp_f32 v43, v43
    s_waitcnt lgkmcnt(1)
    v_mfma_f32_32x32x16_bf16 v[72:87], v[104:107], v[64:67], v[72:87]
    v_cvt_pk_bf16_f32 v68, v40, v41
    v_cvt_pk_bf16_f32 v69, v42, v43
    v_exp_f32 v44, v44
    v_exp_f32 v45, v45
    v_exp_f32 v46, v46
    v_exp_f32 v47, v47
    v_cvt_pk_bf16_f32 v70, v44, v45
    v_cvt_pk_bf16_f32 v71, v46, v47
    s_add_u32 s33, s32, 53248
    buffer_load_dwordx4 v[240:243], v3, s[8:11], s33 offen offset:0
    v_mfma_f32_32x32x16_bf16 v[72:87], v[108:111], v[68:71], v[72:87]
    s_mov_b64 exec, s[30:31]
    ds_read_b128 v[104:107], v98 offset:29696
    ds_read_b128 v[108:111], v98 offset:30208
    s_mov_b64 exec, -1
    v_exp_f32 v48, v48
    v_exp_f32 v49, v49
    v_exp_f32 v50, v50
    v_exp_f32 v51, v51
    v_cvt_pk_bf16_f32 v64, v48, v49
    v_cvt_pk_bf16_f32 v65, v50, v51
    s_waitcnt lgkmcnt(2)
    v_mfma_f32_32x32x16_bf16 v[32:47], v[100:103], v[4:7], v[16:31]
    ds_read_b128 v[100:103], v97 offset:31744
    v_exp_f32 v52, v52
    v_exp_f32 v53, v53
    v_exp_f32 v54, v54
    v_exp_f32 v55, v55
    v_cvt_pk_bf16_f32 v66, v52, v53
    v_cvt_pk_bf16_f32 v67, v54, v55
    v_exp_f32 v56, v56
    v_exp_f32 v57, v57
    v_exp_f32 v58, v58
    v_exp_f32 v59, v59
    s_waitcnt lgkmcnt(1)
    v_mfma_f32_32x32x16_bf16 v[72:87], v[104:107], v[64:67], v[72:87]
    v_cvt_pk_bf16_f32 v68, v56, v57
    v_cvt_pk_bf16_f32 v69, v58, v59
    v_exp_f32 v60, v60
    v_exp_f32 v61, v61
    v_exp_f32 v62, v62
    v_exp_f32 v63, v63
    v_cvt_pk_bf16_f32 v70, v60, v61
    v_cvt_pk_bf16_f32 v71, v62, v63
    s_add_u32 s33, s32, 53248
    buffer_load_dwordx4 v[244:247], v3, s[8:11], s33 offen offset:1024
    v_mfma_f32_32x32x16_bf16 v[72:87], v[108:111], v[68:71], v[72:87]
    s_mov_b64 exec, s[30:31]
    ds_read_b128 v[104:107], v98 offset:30720
    ds_read_b128 v[108:111], v98 offset:31232
    s_mov_b64 exec, -1
    v_exp_f32 v32, v32
    v_exp_f32 v33, v33
    v_exp_f32 v34, v34
    v_exp_f32 v35, v35
    v_cvt_pk_bf16_f32 v64, v32, v33
    v_cvt_pk_bf16_f32 v65, v34, v35
    s_waitcnt lgkmcnt(2)
    v_mfma_f32_32x32x16_bf16 v[48:63], v[100:103], v[4:7], v[16:31]
    v_exp_f32 v36, v36
    v_exp_f32 v37, v37
    v_exp_f32 v38, v38
    v_exp_f32 v39, v39
    v_cvt_pk_bf16_f32 v66, v36, v37
    v_cvt_pk_bf16_f32 v67, v38, v39
    v_exp_f32 v40, v40
    v_exp_f32 v41, v41
    v_exp_f32 v42, v42
    v_exp_f32 v43, v43
    s_waitcnt lgkmcnt(0)
    v_mfma_f32_32x32x16_bf16 v[72:87], v[104:107], v[64:67], v[72:87]
    v_cvt_pk_bf16_f32 v68, v40, v41
    v_cvt_pk_bf16_f32 v69, v42, v43
    v_exp_f32 v44, v44
    v_exp_f32 v45, v45
    v_exp_f32 v46, v46
    v_exp_f32 v47, v47
    v_cvt_pk_bf16_f32 v70, v44, v45
    v_cvt_pk_bf16_f32 v71, v46, v47
    s_add_u32 s33, s32, 53248
    buffer_load_dwordx4 v[248:251], v3, s[8:11], s33 offen offset:2048
    v_mfma_f32_32x32x16_bf16 v[72:87], v[108:111], v[68:71], v[72:87]
    s_mov_b64 exec, s[30:31]
    ds_read_b128 v[104:107], v98 offset:31744
    ds_read_b128 v[108:111], v98 offset:32256
    s_mov_b64 exec, -1
    v_exp_f32 v48, v48
    v_exp_f32 v49, v49
    v_exp_f32 v50, v50
    v_exp_f32 v51, v51
    v_cvt_pk_bf16_f32 v64, v48, v49
    v_cvt_pk_bf16_f32 v65, v50, v51
    v_exp_f32 v52, v52
    v_exp_f32 v53, v53
    v_exp_f32 v54, v54
    v_exp_f32 v55, v55
    v_cvt_pk_bf16_f32 v66, v52, v53
    v_cvt_pk_bf16_f32 v67, v54, v55
    v_exp_f32 v56, v56
    v_exp_f32 v57, v57
    v_exp_f32 v58, v58
    v_exp_f32 v59, v59
    s_waitcnt lgkmcnt(0)
    v_mfma_f32_32x32x16_bf16 v[72:87], v[104:107], v[64:67], v[72:87]
    v_cvt_pk_bf16_f32 v68, v56, v57
    v_cvt_pk_bf16_f32 v69, v58, v59
    v_exp_f32 v60, v60
    v_exp_f32 v61, v61
    v_exp_f32 v62, v62
    v_exp_f32 v63, v63
    v_cvt_pk_bf16_f32 v70, v60, v61
    v_cvt_pk_bf16_f32 v71, v62, v63
    s_add_u32 s33, s32, 53248
    buffer_load_dwordx4 v[252:255], v3, s[8:11], s33 offen offset:3072
    v_mfma_f32_32x32x16_bf16 v[72:87], v[108:111], v[68:71], v[72:87]
    s_cmp_eq_u32 s47, 0
    s_cbranch_scc1 k2_kernel_nopre
    s_mov_b32 m0, 160000
    s_bitcmp1_b32 s3, 1
    s_cbranch_scc1 k2_kernel_preu
    buffer_load_dword v0, s[60:63], s49 offen lds
    s_branch k2_kernel_pre2
k2_kernel_preu:
    buffer_load_dword v0, s[64:67], s49 offen lds
k2_kernel_pre2:
    v_lshl_add_u32 v13, v3, 3, s43
    buffer_load_dword v13, s[12:15], s44 offen lds
k2_kernel_nopre:
    s_nop 15
    s_nop 3
k2_kernel_restart4:
    s_mov_b32 s24, 4
    s_cmp_eq_u32 s25, 4
    s_cbranch_scc1 k2_kernel_rend
    v_cmp_ngt_f32 vcc, s27, v80
    s_cbranch_vccnz k2_kernel_rollback
    s_branch k2_kernel_rend
k2_kernel_renorm:
    v_frexp_exp_i32_f32 v13, v80
    s_nop 0
    v_add_u32 v13, 60, v13
    v_sub_u32 v14, 0, v13
    v_cvt_f32_i32 v15, v13
    v_ldexp_f32 v72, v72, v14
    v_ldexp_f32 v73, v73, v14
    v_ldexp_f32 v74, v74, v14
    v_ldexp_f32 v75, v75, v14
    v_ldexp_f32 v76, v76, v14
    v_ldexp_f32 v77, v77, v14
    v_ldexp_f32 v78, v78, v14
    v_ldexp_f32 v79, v79, v14
    v_ldexp_f32 v80, v80, v14
    s_nop 7
    v_sub_f32 v16, v16, v15
    v_sub_f32 v17, v17, v15
    v_sub_f32 v18, v18, v15
    v_sub_f32 v19, v19, v15
    v_sub_f32 v20, v20, v15
    v_sub_f32 v21, v21, v15
    v_sub_f32 v22, v22, v15
    v_sub_f32 v23, v23, v15
    v_sub_f32 v24, v24, v15
    v_sub_f32 v25, v25, v15
    v_sub_f32 v26, v26, v15
    v_sub_f32 v27, v27, v15
    v_sub_f32 v28, v28, v15
    v_sub_f32 v29, v29, v15
    v_sub_f32 v30, v30, v15
    v_sub_f32 v31, v31, v15
    s_branch k2_kernel_reinit
k2_kernel_rollback:
    s_waitcnt lgkmcnt(0)
    s_mov_b32 s25, s24
    v_mov_b32 v72, v88
    v_mov_b32 v73, v89
    v_mov_b32 v74, v90
    v_mov_b32 v75, v91
    v_mov_b32 v76, v92
    v_mov_b32 v77, v93
    v_mov_b32 v78, v94
    v_mov_b32 v79, v95
    v_mov_b32 v80, v96
    s_sub_u32 s20, s24, 1
    s_lshl_b32 s20, s20, 13
    v_add_u32 v12, s20, v97
    v_mov_b32 v13, 0xff7fffff
    s_mov_b32 s48, 8
k2_kernel_rb1:
    ds_read_b128 v[100:103], v12
    v_add_u32 v12, 1024, v12
    s_waitcnt lgkmcnt(0)
    v_mfma_f32_32x32x16_bf16 v[48:63], v[100:103], v[4:7], v[16:31]
    s_nop 15
    s_nop 3
    v_max3_f32 v13, v48, v49, v13
    v_max3_f32 v13, v50, v51, v13
    v_max3_f32 v13, v52, v53, v13
    v_max3_f32 v13, v54, v55, v13
    v_max3_f32 v13, v56, v57, v13
    v_max3_f32 v13, v58, v59, v13
    v_max3_f32 v13, v60, v61, v13
    v_max3_f32 v13, v62, v63, v13
    s_sub_u32 s48, s48, 1
    s_cmp_lg_u32 s48, 0
    s_cbranch_scc1 k2_kernel_rb1
    v_mov_b32 v14, v13
    s_nop 1
    v_permlane32_swap_b32 v14, v13
    s_nop 1
    v_max_f32 v13, v14, v13
    v_ceil_f32 v13, v13
    v_add_f32 v13, 0x42700000, v13
    v_max_f32 v13, 0, v13
    v_cvt_i32_f32 v14, v13
    v_sub_u32 v14, 0, v14
    v_ldexp_f32 v72, v72, v14
    v_ldexp_f32 v73, v73, v14
    v_ldexp_f32 v74, v74, v14
    v_ldexp_f32 v75, v75, v14
    v_ldexp_f32 v76, v76, v14
    v_ldexp_f32 v77, v77, v14
    v_ldexp_f32 v78, v78, v14
    v_ldexp_f32 v79, v79, v14
    v_ldexp_f32 v80, v80, v14
    v_sub_f32 v16, v16, v13
    v_sub_f32 v17, v17, v13
    v_sub_f32 v18, v18, v13
    v_sub_f32 v19, v19, v13
    v_sub_f32 v20, v20, v13
    v_sub_f32 v21, v21, v13
    v_sub_f32 v22, v22, v13
    v_sub_f32 v23, v23, v13
    v_sub_f32 v24, v24, v13
    v_sub_f32 v25, v25, v13
    v_sub_f32 v26, v26, v13
    v_sub_f32 v27, v27, v13
    v_sub_f32 v28, v28, v13
    v_sub_f32 v29, v29, v13
    v_sub_f32 v30, v30, v13
    v_sub_f32 v31, v31, v13
    v_add_u32 v12, s20, v97
    v_add_u32 v13, s20, v98
    s_mov_b32 s48, 8
k2_kernel_rb2:
    ds_read_b128 v[100:103], v12
    s_mov_b64 exec, s[30:31]
    ds_read_b128 v[104:107], v13
    ds_read_b128 v[108:111], v13 offset:512
    s_mov_b64 exec, -1
    v_add_u32 v12, 1024, v12
    v_add_u32 v13, 1024, v13
    s_waitcnt lgkmcnt(0)
    v_mfma_f32_32x32x16_bf16 v[48:63], v[100:103], v[4:7], v[16:31]
    s_nop 15
    s_nop 3
    v_exp_f32 v48, v48
    v_exp_f32 v49, v49
    v_exp_f32 v50, v50
    v_exp_f32 v51, v51
    v_cvt_pk_bf16_f32 v64, v48, v49
    v_cvt_pk_bf16_f32 v65, v50, v51
    v_exp_f32 v52, v52
    v_exp_f32 v53, v53
    v_exp_f32 v54, v54
    v_exp_f32 v55, v55
    v_cvt_pk_bf16_f32 v66, v52, v53
    v_cvt_pk_bf16_f32 v67, v54, v55
    v_exp_f32 v56, v56
    v_exp_f32 v57, v57
    v_exp_f32 v58, v58
    v_exp_f32 v59, v59
    v_cvt_pk_bf16_f32 v68, v56, v57
    v_cvt_pk_bf16_f32 v69, v58, v59
    v_exp_f32 v60, v60
    v_exp_f32 v61, v61
    v_exp_f32 v62, v62
    v_exp_f32 v63, v63
    v_cvt_pk_bf16_f32 v70, v60, v61
    v_cvt_pk_bf16_f32 v71, v62, v63
    s_nop 1
    v_mfma_f32_32x32x16_bf16 v[72:87], v[104:107], v[64:67], v[72:87]
    v_mfma_f32_32x32x16_bf16 v[72:87], v[108:111], v[68:71], v[72:87]
    s_sub_u32 s48, s48, 1
    s_cmp_lg_u32 s48, 0
    s_cbranch_scc1 k2_kernel_rb2
    s_nop 15
    s_nop 3
k2_kernel_reinit:
    s_waitcnt lgkmcnt(0)
    s_lshl_b32 s20, s24, 13
    v_add_u32 v12, s20, v97
    v_add_u32 v13, s20, v98
    ds_read_b128 v[100:103], v12
    s_waitcnt lgkmcnt(0)
    v_mfma_f32_32x32x16_bf16 v[32:47], v[100:103], v[4:7], v[16:31]
    ds_read_b128 v[100:103], v12 offset:1024
    s_mov_b64 exec, s[30:31]
    ds_read_b128 v[104:107], v13
    ds_read_b128 v[108:111], v13 offset:512
    s_mov_b64 exec, -1
    s_nop 11
    s_cmp_eq_u32 s24, 0
    s_cbranch_scc1 k2_kernel_restart0
    s_cmp_eq_u32 s24, 1
    s_cbranch_scc1 k2_kernel_restart1
    s_cmp_eq_u32 s24, 2
    s_cbranch_scc1 k2_kernel_restart2
    s_cmp_eq_u32 s24, 3
    s_cbranch_scc1 k2_kernel_restart3
    s_branch k2_kernel_restart4
k2_kernel_rend:
    s_setprio 0
    v_frexp_exp_i32_f32 v13, v80
    s_nop 0
    v_add_u32 v13, 60, v13
    v_sub_u32 v14, 0, v13
    v_cvt_f32_i32 v15, v13
    v_ldexp_f32 v72, v72, v14
    v_ldexp_f32 v73, v73, v14
    v_ldexp_f32 v74, v74, v14
    v_ldexp_f32 v75, v75, v14
    v_ldexp_f32 v76, v76, v14
    v_ldexp_f32 v77, v77, v14
    v_ldexp_f32 v78, v78, v14
    v_ldexp_f32 v79, v79, v14
    v_ldexp_f32 v80, v80, v14
    v_sub_f32 v16, v16, v15
    s_mul_i32 s33, s45, 2560
    s_add_u32 s33, s33, 135424
    v_lshlrev_b32 v14, 2, v2
    v_add_u32 v14, s33, v14
    s_cmp_eq_u32 s46, 0
    s_cbranch_scc1 k2_kernel_nopub
    ds_write_b32 v14, v72 offset:0
    ds_write_b32 v14, v73 offset:256
    ds_write_b32 v14, v74 offset:512
    ds_write_b32 v14, v75 offset:768
    ds_write_b32 v14, v76 offset:1024
    ds_write_b32 v14, v77 offset:1280
    ds_write_b32 v14, v78 offset:1536
    ds_write_b32 v14, v79 offset:1792
    ds_write_b32 v14, v80 offset:2048
    ds_write_b32 v14, v16 offset:2304
k2_kernel_nopub:
    s_waitcnt lgkmcnt(0)
    s_barrier
    s_cmp_lg_u32 s46, 0
    s_cbranch_scc1 k2_kernel_nomerge
    ds_read_b32 v32, v14 offset:0
    ds_read_b32 v33, v14 offset:256
    ds_read_b32 v34, v14 offset:512
    ds_read_b32 v35, v14 offset:768
    ds_read_b32 v36, v14 offset:1024
    ds_read_b32 v37, v14 offset:1280
    ds_read_b32 v38, v14 offset:1536
    ds_read_b32 v39, v14 offset:1792
    ds_read_b32 v40, v14 offset:2048
    ds_read_b32 v41, v14 offset:2304
    s_waitcnt lgkmcnt(0)
    v_min_f32 v13, v16, v41
    v_sub_f32 v14, v13, v16
    v_sub_f32 v15, v13, v41
    v_exp_f32 v14, v14
    v_exp_f32 v15, v15
    s_nop 0
    v_mul_f32 v72, v72, v14
    v_mul_f32 v73, v73, v14
    v_mul_f32 v74, v74, v14
    v_mul_f32 v75, v75, v14
    v_mul_f32 v76, v76, v14
    v_mul_f32 v77, v77, v14
    v_mul_f32 v78, v78, v14
    v_mul_f32 v79, v79, v14
    v_mul_f32 v80, v80, v14
    v_fmac_f32 v72, v32, v15
    v_fmac_f32 v73, v33, v15
    v_fmac_f32 v74, v34, v15
    v_fmac_f32 v75, v35, v15
    v_fmac_f32 v76, v36, v15
    v_fmac_f32 v77, v37, v15
    v_fmac_f32 v78, v38, v15
    v_fmac_f32 v79, v39, v15
    v_fmac_f32 v80, v40, v15
    v_rcp_f32 v13, v80
    s_nop 0
    v_mul_f32 v72, v72, v13
    v_mul_f32 v73, v73, v13
    v_mul_f32 v74, v74, v13
    v_mul_f32 v75, v75, v13
    v_mul_f32 v76, v76, v13
    v_mul_f32 v77, v77, v13
    v_mul_f32 v78, v78, v13
    v_mul_f32 v79, v79, v13
    v_cvt_pk_bf16_f32 v32, v72, v73
    v_cvt_pk_bf16_f32 v33, v74, v75
    v_cvt_pk_bf16_f32 v34, v76, v77
    v_cvt_pk_bf16_f32 v35, v78, v79
    v_bfe_u32 v14, v2, 4, 1
    s_lshl_b32 s33, s45, 1
    v_add_u32 v14, s33, v14
    v_mul_u32_u24 v14, 528, v14
    v_and_b32 v15, 15, v2
    v_lshl_add_u32 v14, v15, 5, v14
    v_lshrrev_b32 v15, 5, v2
    v_lshl_add_u32 v14, v15, 3, v14
    v_add_u32 v14, 131072, v14
    ds_write_b64 v14, v[32:33]
    ds_write_b64 v14, v[34:35] offset:16
    s_waitcnt lgkmcnt(0)
k2_kernel_nomerge:
    s_barrier
    v_and_b32 v14, 7, v2
    v_mul_u32_u24 v14, 528, v14
    v_lshrrev_b32 v15, 4, v2
    v_lshl_add_u32 v14, v15, 4, v14
    v_add_u32 v14, 131072, v14
    ds_read_b128 v[32:35], v14 offset:0
    ds_read_b128 v[36:39], v14 offset:64
    ds_read_b128 v[40:43], v14 offset:128
    ds_read_b128 v[44:47], v14 offset:192
    ds_read_b128 v[48:51], v14 offset:256
    ds_read_b128 v[52:55], v14 offset:320
    ds_read_b128 v[56:59], v14 offset:384
    ds_read_b128 v[60:63], v14 offset:448
    s_waitcnt vmcnt(2)
    s_cmp_lg_u32 s47, 0
    s_cbranch_scc1 k2_kernel_proj1
    s_waitcnt vmcnt(0)
    s_waitcnt lgkmcnt(7)
    v_mfma_f32_16x16x32_bf16 v[112:115], v[128:131], v[32:35], 0
    v_mfma_f32_16x16x32_bf16 v[116:119], v[160:163], v[32:35], 0
    v_mfma_f32_16x16x32_bf16 v[120:123], v[192:195], v[32:35], 0
    v_mfma_f32_16x16x32_bf16 v[124:127], v[224:227], v[32:35], 0
    s_waitcnt lgkmcnt(6)
    v_mfma_f32_16x16x32_bf16 v[112:115], v[132:135], v[36:39], v[112:115]
    v_mfma_f32_16x16x32_bf16 v[116:119], v[164:167], v[36:39], v[116:119]
    v_mfma_f32_16x16x32_bf16 v[120:123], v[196:199], v[36:39], v[120:123]
    v_mfma_f32_16x16x32_bf16 v[124:127], v[228:231], v[36:39], v[124:127]
    s_waitcnt lgkmcnt(5)
    v_mfma_f32_16x16x32_bf16 v[112:115], v[136:139], v[40:43], v[112:115]
    v_mfma_f32_16x16x32_bf16 v[116:119], v[168:171], v[40:43], v[116:119]
    v_mfma_f32_16x16x32_bf16 v[120:123], v[200:203], v[40:43], v[120:123]
    v_mfma_f32_16x16x32_bf16 v[124:127], v[232:235], v[40:43], v[124:127]
    s_waitcnt lgkmcnt(4)
    v_mfma_f32_16x16x32_bf16 v[112:115], v[140:143], v[44:47], v[112:115]
    v_mfma_f32_16x16x32_bf16 v[116:119], v[172:175], v[44:47], v[116:119]
    v_mfma_f32_16x16x32_bf16 v[120:123], v[204:207], v[44:47], v[120:123]
    v_mfma_f32_16x16x32_bf16 v[124:127], v[236:239], v[44:47], v[124:127]
    s_waitcnt lgkmcnt(3)
    v_mfma_f32_16x16x32_bf16 v[112:115], v[144:147], v[48:51], v[112:115]
    v_mfma_f32_16x16x32_bf16 v[116:119], v[176:179], v[48:51], v[116:119]
    v_mfma_f32_16x16x32_bf16 v[120:123], v[208:211], v[48:51], v[120:123]
    v_mfma_f32_16x16x32_bf16 v[124:127], v[240:243], v[48:51], v[124:127]
    s_waitcnt lgkmcnt(2)
    v_mfma_f32_16x16x32_bf16 v[112:115], v[148:151], v[52:55], v[112:115]
    v_mfma_f32_16x16x32_bf16 v[116:119], v[180:183], v[52:55], v[116:119]
    v_mfma_f32_16x16x32_bf16 v[120:123], v[212:215], v[52:55], v[120:123]
    v_mfma_f32_16x16x32_bf16 v[124:127], v[244:247], v[52:55], v[124:127]
    s_waitcnt lgkmcnt(1)
    v_mfma_f32_16x16x32_bf16 v[112:115], v[152:155], v[56:59], v[112:115]
    v_mfma_f32_16x16x32_bf16 v[116:119], v[184:187], v[56:59], v[116:119]
    v_mfma_f32_16x16x32_bf16 v[120:123], v[216:219], v[56:59], v[120:123]
    v_mfma_f32_16x16x32_bf16 v[124:127], v[248:251], v[56:59], v[124:127]
    s_waitcnt lgkmcnt(0)
    v_mfma_f32_16x16x32_bf16 v[112:115], v[156:159], v[60:63], v[112:115]
    v_mfma_f32_16x16x32_bf16 v[116:119], v[188:191], v[60:63], v[116:119]
    v_mfma_f32_16x16x32_bf16 v[120:123], v[220:223], v[60:63], v[120:123]
    v_mfma_f32_16x16x32_bf16 v[124:127], v[252:255], v[60:63], v[124:127]
    v_mov_b32 v4, v8
    v_mov_b32 v5, v9
    v_mov_b32 v6, v10
    v_mov_b32 v7, v11
    v_lshl_add_u32 v13, s3, 6, v2
    s_lshr_b32 s20, s2, 3
    s_and_b32 s21, s2, 7
    s_lshr_b32 s21, s21, 1
    s_mul_i32 s21, s21, 896
    s_mul_i32 s22, s20, 57344
    s_add_u32 s49, s21, s22
    v_bfe_u32 v14, v13, 3, 4
    v_mul_u32_u24 v14, 3584, v14
    v_and_b32 v15, 7, v13
    v_lshl_add_u32 v0, v15, 7, v14
    s_mul_i32 s44, s20, 57344
    s_lshl_b32 s43, s3, 13
    s_mov_b32 s47, 1
    s_branch k2_kernel_round
k2_kernel_proj1:
    s_lshl_b32 s33, s3, 6
    v_lshl_add_u32 v4, v15, 2, s33
    v_lshlrev_b32 v5, 2, v4
    v_add_u32 v5, 145664, v5
    v_and_b32 v6, 7, v2
    v_lshlrev_b32 v6, 10, v6
    v_lshl_add_u32 v6, v4, 1, v6
    v_add_u32 v7, 151808, v6
    s_waitcnt lgkmcnt(7)
    v_mfma_f32_16x16x32_bf16 v[112:115], v[128:131], v[32:35], v[112:115]
    v_mfma_f32_16x16x32_bf16 v[116:119], v[160:163], v[32:35], v[116:119]
    v_mfma_f32_16x16x32_bf16 v[120:123], v[192:195], v[32:35], v[120:123]
    v_mfma_f32_16x16x32_bf16 v[124:127], v[224:227], v[32:35], v[124:127]
    s_waitcnt lgkmcnt(6)
    v_mfma_f32_16x16x32_bf16 v[112:115], v[132:135], v[36:39], v[112:115]
    v_mfma_f32_16x16x32_bf16 v[116:119], v[164:167], v[36:39], v[116:119]
    v_mfma_f32_16x16x32_bf16 v[120:123], v[196:199], v[36:39], v[120:123]
    v_mfma_f32_16x16x32_bf16 v[124:127], v[228:231], v[36:39], v[124:127]
    s_waitcnt lgkmcnt(5)
    v_mfma_f32_16x16x32_bf16 v[112:115], v[136:139], v[40:43], v[112:115]
    v_mfma_f32_16x16x32_bf16 v[116:119], v[168:171], v[40:43], v[116:119]
    v_mfma_f32_16x16x32_bf16 v[120:123], v[200:203], v[40:43], v[120:123]
    v_mfma_f32_16x16x32_bf16 v[124:127], v[232:235], v[40:43], v[124:127]
    s_waitcnt lgkmcnt(4)
    v_mfma_f32_16x16x32_bf16 v[112:115], v[140:143], v[44:47], v[112:115]
    v_mfma_f32_16x16x32_bf16 v[116:119], v[172:175], v[44:47], v[116:119]
    v_mfma_f32_16x16x32_bf16 v[120:123], v[204:207], v[44:47], v[120:123]
    v_mfma_f32_16x16x32_bf16 v[124:127], v[236:239], v[44:47], v[124:127]
    s_waitcnt lgkmcnt(3)
    v_mfma_f32_16x16x32_bf16 v[112:115], v[144:147], v[48:51], v[112:115]
    v_mfma_f32_16x16x32_bf16 v[116:119], v[176:179], v[48:51], v[116:119]
    v_mfma_f32_16x16x32_bf16 v[120:123], v[208:211], v[48:51], v[120:123]
    v_mfma_f32_16x16x32_bf16 v[124:127], v[240:243], v[48:51], v[124:127]
    s_waitcnt lgkmcnt(2)
    v_mfma_f32_16x16x32_bf16 v[112:115], v[148:151], v[52:55], v[112:115]
    v_mfma_f32_16x16x32_bf16 v[116:119], v[180:183], v[52:55], v[116:119]
    v_mfma_f32_16x16x32_bf16 v[120:123], v[212:215], v[52:55], v[120:123]
    v_mfma_f32_16x16x32_bf16 v[124:127], v[244:247], v[52:55], v[124:127]
    s_waitcnt lgkmcnt(1)
    v_mfma_f32_16x16x32_bf16 v[112:115], v[152:155], v[56:59], v[112:115]
    v_mfma_f32_16x16x32_bf16 v[116:119], v[184:187], v[56:59], v[116:119]
    v_mfma_f32_16x16x32_bf16 v[120:123], v[216:219], v[56:59], v[120:123]
    v_mfma_f32_16x16x32_bf16 v[124:127], v[248:251], v[56:59], v[124:127]
    s_waitcnt lgkmcnt(0)
    v_mfma_f32_16x16x32_bf16 v[112:115], v[156:159], v[60:63], v[112:115]
    v_mfma_f32_16x16x32_bf16 v[116:119], v[188:191], v[60:63], v[116:119]
    v_mfma_f32_16x16x32_bf16 v[120:123], v[220:223], v[60:63], v[120:123]
    v_mfma_f32_16x16x32_bf16 v[124:127], v[252:255], v[60:63], v[124:127]
    ds_read_b128 v[64:67], v5 offset:0
    ds_read_b128 v[68:71], v5 offset:64
    ds_read_b128 v[72:75], v5 offset:128
    ds_read_b128 v[76:79], v5 offset:192
    ds_read_b128 v[80:83], v5 offset:2048
    ds_read_b128 v[84:87], v5 offset:2112
    ds_read_b128 v[88:91], v5 offset:2176
    ds_read_b128 v[92:95], v5 offset:2240
    ds_read_b128 v[96:99], v5 offset:4096
    ds_read_b128 v[100:103], v5 offset:4160
    ds_read_b128 v[104:107], v5 offset:4224
    ds_read_b128 v[108:111], v5 offset:4288
    s_waitcnt lgkmcnt(4)
    ds_read_b64 v[16:17], v7 offset:0
    ds_read_b64 v[18:19], v7 offset:32
    ds_read_b64 v[20:21], v7 offset:64
    ds_read_b64 v[22:23], v7 offset:96
    s_waitcnt lgkmcnt(0)
    s_nop 3
    v_cvt_pk_bf16_f32 v7, v112, v113
    v_lshlrev_b32 v112, 16, v7
    v_and_b32 v113, 0xffff0000, v7
    v_cvt_pk_bf16_f32 v7, v114, v115
    v_lshlrev_b32 v114, 16, v7
    v_and_b32 v115, 0xffff0000, v7
    v_cvt_pk_bf16_f32 v7, v116, v117
    v_lshlrev_b32 v116, 16, v7
    v_and_b32 v117, 0xffff0000, v7
    v_cvt_pk_bf16_f32 v7, v118, v119
    v_lshlrev_b32 v118, 16, v7
    v_and_b32 v119, 0xffff0000, v7
    v_cvt_pk_bf16_f32 v7, v120, v121
    v_lshlrev_b32 v120, 16, v7
    v_and_b32 v121, 0xffff0000, v7
    v_cvt_pk_bf16_f32 v7, v122, v123
    v_lshlrev_b32 v122, 16, v7
    v_and_b32 v123, 0xffff0000, v7
    v_cvt_pk_bf16_f32 v7, v124, v125
    v_lshlrev_b32 v124, 16, v7
    v_and_b32 v125, 0xffff0000, v7
    v_cvt_pk_bf16_f32 v7, v126, v127
    v_lshlrev_b32 v126, 16, v7
    v_and_b32 v127, 0xffff0000, v7
    v_mul_f32 v112, v112, v64
    v_mul_f32 v113, v113, v65
    v_mul_f32 v114, v114, v66
    v_mul_f32 v115, v115, v67
    v_mul_f32 v116, v116, v68
    v_mul_f32 v117, v117, v69
    v_mul_f32 v118, v118, v70
    v_mul_f32 v119, v119, v71
    v_mul_f32 v120, v120, v72
    v_mul_f32 v121, v121, v73
    v_mul_f32 v122, v122, v74
    v_mul_f32 v123, v123, v75
    v_mul_f32 v124, v124, v76
    v_mul_f32 v125, v125, v77
    v_mul_f32 v126, v126, v78
    v_mul_f32 v127, v127, v79
    v_cvt_pk_bf16_f32 v7, v112, v113
    v_lshlrev_b32 v112, 16, v7
    v_and_b32 v113, 0xffff0000, v7
    v_cvt_pk_bf16_f32 v7, v114, v115
    v_lshlrev_b32 v114, 16, v7
    v_and_b32 v115, 0xffff0000, v7
    v_cvt_pk_bf16_f32 v7, v116, v117
    v_lshlrev_b32 v116, 16, v7
    v_and_b32 v117, 0xffff0000, v7
    v_cvt_pk_bf16_f32 v7, v118, v119
    v_lshlrev_b32 v118, 16, v7
    v_and_b32 v119, 0xffff0000, v7
    v_cvt_pk_bf16_f32 v7, v120, v121
    v_lshlrev_b32 v120, 16, v7
    v_and_b32 v121, 0xffff0000, v7
    v_cvt_pk_bf16_f32 v7, v122, v123
    v_lshlrev_b32 v122, 16, v7
    v_and_b32 v123, 0xffff0000, v7
    v_cvt_pk_bf16_f32 v7, v124, v125
    v_lshlrev_b32 v124, 16, v7
    v_and_b32 v125, 0xffff0000, v7
    v_cvt_pk_bf16_f32 v7, v126, v127
    v_lshlrev_b32 v126, 16, v7
    v_and_b32 v127, 0xffff0000, v7
    v_lshlrev_b32 v128, 16, v16
    v_and_b32 v129, 0xffff0000, v16
    v_lshlrev_b32 v130, 16, v17
    v_and_b32 v131, 0xffff0000, v17
    v_lshlrev_b32 v132, 16, v18
    v_and_b32 v133, 0xffff0000, v18
    v_lshlrev_b32 v134, 16, v19
    v_and_b32 v135, 0xffff0000, v19
    v_lshlrev_b32 v136, 16, v20
    v_and_b32 v137, 0xffff0000, v20
    v_lshlrev_b32 v138, 16, v21
    v_and_b32 v139, 0xffff0000, v21
    v_lshlrev_b32 v140, 16, v22
    v_and_b32 v141, 0xffff0000, v22
    v_lshlrev_b32 v142, 16, v23
    v_and_b32 v143, 0xffff0000, v23
    v_add_f32 v128, v128, v112
    v_add_f32 v129, v129, v113
    v_add_f32 v130, v130, v114
    v_add_f32 v131, v131, v115
    v_add_f32 v132, v132, v116
    v_add_f32 v133, v133, v117
    v_add_f32 v134, v134, v118
    v_add_f32 v135, v135, v119
    v_add_f32 v136, v136, v120
    v_add_f32 v137, v137, v121
    v_add_f32 v138, v138, v122
    v_add_f32 v139, v139, v123
    v_add_f32 v140, v140, v124
    v_add_f32 v141, v141, v125
    v_add_f32 v142, v142, v126
    v_add_f32 v143, v143, v127
    v_cvt_pk_bf16_f32 v144, v128, v129
    v_cvt_pk_bf16_f32 v145, v130, v131
    v_cvt_pk_bf16_f32 v146, v132, v133
    v_cvt_pk_bf16_f32 v147, v134, v135
    v_cvt_pk_bf16_f32 v148, v136, v137
    v_cvt_pk_bf16_f32 v149, v138, v139
    v_cvt_pk_bf16_f32 v150, v140, v141
    v_cvt_pk_bf16_f32 v151, v142, v143
    v_lshlrev_b32 v128, 16, v144
    v_and_b32 v129, 0xffff0000, v144
    v_lshlrev_b32 v130, 16, v145
    v_and_b32 v131, 0xffff0000, v145
    v_lshlrev_b32 v132, 16, v146
    v_and_b32 v133, 0xffff0000, v146
    v_lshlrev_b32 v134, 16, v147
    v_and_b32 v135, 0xffff0000, v147
    v_lshlrev_b32 v136, 16, v148
    v_and_b32 v137, 0xffff0000, v148
    v_lshlrev_b32 v138, 16, v149
    v_and_b32 v139, 0xffff0000, v149
    v_lshlrev_b32 v140, 16, v150
    v_and_b32 v141, 0xffff0000, v150
    v_lshlrev_b32 v142, 16, v151
    v_and_b32 v143, 0xffff0000, v151
    v_and_b32 v8, 15, v2
    v_cmp_gt_u32 vcc, 8, v8
    s_add_u32 s38, s37, 12582912
    s_and_saveexec_b64 s[40:41], vcc
    buffer_store_dwordx2 v[144:145], v6, s[8:11], s38 offen offset:0
    buffer_store_dwordx2 v[146:147], v6, s[8:11], s38 offen offset:32
    buffer_store_dwordx2 v[148:149], v6, s[8:11], s38 offen offset:64
    buffer_store_dwordx2 v[150:151], v6, s[8:11], s38 offen offset:96
    s_mov_b64 exec, s[40:41]
    v_add_f32 v10, v128, v129
    v_add_f32 v10, v10, v130
    v_add_f32 v10, v10, v131
    v_add_f32 v10, v10, v132
    v_add_f32 v10, v10, v133
    v_add_f32 v10, v10, v134
    v_add_f32 v10, v10, v135
    v_add_f32 v10, v10, v136
    v_add_f32 v10, v10, v137
    v_add_f32 v10, v10, v138
    v_add_f32 v10, v10, v139
    v_add_f32 v10, v10, v140
    v_add_f32 v10, v10, v141
    v_add_f32 v10, v10, v142
    v_add_f32 v10, v10, v143
    v_mov_b32 v9, v10
    s_nop 1
    v_permlane16_swap_b32 v9, v10
    s_nop 1
    v_add_f32 v10, v9, v10
    v_mov_b32 v9, v10
    s_nop 1
    v_permlane32_swap_b32 v9, v10
    s_nop 1
    v_add_f32 v10, v9, v10
    s_mov_b32 s42, 0x3c800000
    v_mul_f32 v10, s42, v10
    v_sub_f32 v160, v128, v10
    v_mul_f32 v11, v160, v160
    v_sub_f32 v160, v129, v10
    v_fmac_f32 v11, v160, v160
    v_sub_f32 v160, v130, v10
    v_fmac_f32 v11, v160, v160
    v_sub_f32 v160, v131, v10
    v_fmac_f32 v11, v160, v160
    v_sub_f32 v160, v132, v10
    v_fmac_f32 v11, v160, v160
    v_sub_f32 v160, v133, v10
    v_fmac_f32 v11, v160, v160
    v_sub_f32 v160, v134, v10
    v_fmac_f32 v11, v160, v160
    v_sub_f32 v160, v135, v10
    v_fmac_f32 v11, v160, v160
    v_sub_f32 v160, v136, v10
    v_fmac_f32 v11, v160, v160
    v_sub_f32 v160, v137, v10
    v_fmac_f32 v11, v160, v160
    v_sub_f32 v160, v138, v10
    v_fmac_f32 v11, v160, v160
    v_sub_f32 v160, v139, v10
    v_fmac_f32 v11, v160, v160
    v_sub_f32 v160, v140, v10
    v_fmac_f32 v11, v160, v160
    v_sub_f32 v160, v141, v10
    v_fmac_f32 v11, v160, v160
    v_sub_f32 v160, v142, v10
    v_fmac_f32 v11, v160, v160
    v_sub_f32 v160, v143, v10
    v_fmac_f32 v11, v160, v160
    v_mov_b32 v9, v11
    s_nop 1
    v_permlane16_swap_b32 v9, v11
    s_nop 1
    v_add_f32 v11, v9, v11
    v_mov_b32 v9, v11
    s_nop 1
    v_permlane32_swap_b32 v9, v11
    s_nop 1
    v_add_f32 v11, v9, v11
    v_lshlrev_b32 v9, 3, v2
    s_lshl_b32 s39, s3, 6
    v_add_u32 v9, s39, v9
    v_cmp_gt_u32 vcc, 8, v2
    s_and_saveexec_b64 s[40:41], vcc
    ds_write_b64 v9, v[10:11]
    s_mov_b64 exec, s[40:41]
    s_waitcnt lgkmcnt(0)
    s_barrier
    v_and_b32 v9, 7, v2
    v_lshlrev_b32 v9, 3, v9
    ds_read_b64 v[160:161], v9 offset:0
    ds_read_b64 v[162:163], v9 offset:64
    ds_read_b64 v[164:165], v9 offset:128
    ds_read_b64 v[166:167], v9 offset:192
    ds_read_b64 v[168:169], v9 offset:256
    ds_read_b64 v[170:171], v9 offset:320
    ds_read_b64 v[172:173], v9 offset:384
    ds_read_b64 v[174:175], v9 offset:448
    s_waitcnt lgkmcnt(0)
    v_add_f32 v10, v160, v162
    v_add_f32 v11, v161, v163
    v_add_f32 v10, v10, v164
    v_add_f32 v11, v11, v165
    v_add_f32 v10, v10, v166
    v_add_f32 v11, v11, v167
    v_add_f32 v10, v10, v168
    v_add_f32 v11, v11, v169
    v_add_f32 v10, v10, v170
    v_add_f32 v11, v11, v171
    v_add_f32 v10, v10, v172
    v_add_f32 v11, v11, v173
    v_add_f32 v10, v10, v174
    v_add_f32 v11, v11, v175
    s_mov_b32 s42, 0x3e000000
    v_mul_f32 v10, s42, v10
    v_sub_f32 v160, v160, v10
    v_mul_f32 v176, v160, v160
    v_sub_f32 v162, v162, v10
    v_fmac_f32 v176, v162, v162
    v_sub_f32 v164, v164, v10
    v_fmac_f32 v176, v164, v164
    v_sub_f32 v166, v166, v10
    v_fmac_f32 v176, v166, v166
    v_sub_f32 v168, v168, v10
    v_fmac_f32 v176, v168, v168
    v_sub_f32 v170, v170, v10
    v_fmac_f32 v176, v170, v170
    v_sub_f32 v172, v172, v10
    v_fmac_f32 v176, v172, v172
    v_sub_f32 v174, v174, v10
    v_fmac_f32 v176, v174, v174
    s_mov_b32 s42, 0x42800000
    v_fmac_f32 v11, s42, v176
    s_mov_b32 s42, 0x3b000000
    v_mov_b32 v9, 0x3727c5ac
    v_fma_f32 v11, v11, s42, v9
    v_rsq_f32 v11, v11
    v_sub_f32 v128, v128, v10
    v_sub_f32 v129, v129, v10
    v_sub_f32 v130, v130, v10
    v_sub_f32 v131, v131, v10
    v_sub_f32 v132, v132, v10
    v_sub_f32 v133, v133, v10
    v_sub_f32 v134, v134, v10
    v_sub_f32 v135, v135, v10
    v_sub_f32 v136, v136, v10
    v_sub_f32 v137, v137, v10
    v_sub_f32 v138, v138, v10
    v_sub_f32 v139, v139, v10
    v_sub_f32 v140, v140, v10
    v_sub_f32 v141, v141, v10
    v_sub_f32 v142, v142, v10
    v_sub_f32 v143, v143, v10
    v_mul_f32 v128, v128, v11
    v_mul_f32 v129, v129, v11
    v_mul_f32 v130, v130, v11
    v_mul_f32 v131, v131, v11
    v_mul_f32 v132, v132, v11
    v_mul_f32 v133, v133, v11
    v_mul_f32 v134, v134, v11
    v_mul_f32 v135, v135, v11
    v_mul_f32 v136, v136, v11
    v_mul_f32 v137, v137, v11
    v_mul_f32 v138, v138, v11
    v_mul_f32 v139, v139, v11
    v_mul_f32 v140, v140, v11
    v_mul_f32 v141, v141, v11
    v_mul_f32 v142, v142, v11
    v_mul_f32 v143, v143, v11
    v_add_f32 v96, 1.0, v96
    v_add_f32 v97, 1.0, v97
    v_add_f32 v98, 1.0, v98
    v_add_f32 v99, 1.0, v99
    v_add_f32 v100, 1.0, v100
    v_add_f32 v101, 1.0, v101
    v_add_f32 v102, 1.0, v102
    v_add_f32 v103, 1.0, v103
    v_add_f32 v104, 1.0, v104
    v_add_f32 v105, 1.0, v105
    v_add_f32 v106, 1.0, v106
    v_add_f32 v107, 1.0, v107
    v_add_f32 v108, 1.0, v108
    v_add_f32 v109, 1.0, v109
    v_add_f32 v110, 1.0, v110
    v_add_f32 v111, 1.0, v111
    v_cvt_pk_bf16_f32 v7, v96, v97
    v_lshlrev_b32 v96, 16, v7
    v_and_b32 v97, 0xffff0000, v7
    v_cvt_pk_bf16_f32 v7, v98, v99
    v_lshlrev_b32 v98, 16, v7
    v_and_b32 v99, 0xffff0000, v7
    v_cvt_pk_bf16_f32 v7, v100, v101
    v_lshlrev_b32 v100, 16, v7
    v_and_b32 v101, 0xffff0000, v7
    v_cvt_pk_bf16_f32 v7, v102, v103
    v_lshlrev_b32 v102, 16, v7
    v_and_b32 v103, 0xffff0000, v7
    v_cvt_pk_bf16_f32 v7, v104, v105
    v_lshlrev_b32 v104, 16, v7
    v_and_b32 v105, 0xffff0000, v7
    v_cvt_pk_bf16_f32 v7, v106, v107
    v_lshlrev_b32 v106, 16, v7
    v_and_b32 v107, 0xffff0000, v7
    v_cvt_pk_bf16_f32 v7, v108, v109
    v_lshlrev_b32 v108, 16, v7
    v_and_b32 v109, 0xffff0000, v7
    v_cvt_pk_bf16_f32 v7, v110, v111
    v_lshlrev_b32 v110, 16, v7
    v_and_b32 v111, 0xffff0000, v7
    v_fma_f32 v128, v128, v96, v80
    v_fma_f32 v129, v129, v97, v81
    v_fma_f32 v130, v130, v98, v82
    v_fma_f32 v131, v131, v99, v83
    v_fma_f32 v132, v132, v100, v84
    v_fma_f32 v133, v133, v101, v85
    v_fma_f32 v134, v134, v102, v86
    v_fma_f32 v135, v135, v103, v87
    v_fma_f32 v136, v136, v104, v88
    v_fma_f32 v137, v137, v105, v89
    v_fma_f32 v138, v138, v106, v90
    v_fma_f32 v139, v139, v107, v91
    v_fma_f32 v140, v140, v108, v92
    v_fma_f32 v141, v141, v109, v93
    v_fma_f32 v142, v142, v110, v94
    v_fma_f32 v143, v143, v111, v95
    v_cvt_pk_bf16_f32 v144, v128, v129
    v_cvt_pk_bf16_f32 v145, v130, v131
    v_cvt_pk_bf16_f32 v146, v132, v133
    v_cvt_pk_bf16_f32 v147, v134, v135
    v_cvt_pk_bf16_f32 v148, v136, v137
    v_cvt_pk_bf16_f32 v149, v138, v139
    v_cvt_pk_bf16_f32 v150, v140, v141
    v_cvt_pk_bf16_f32 v151, v142, v143
    v_and_b32 v8, 7, v2
    s_and_b32 s43, s2, 3
    s_lshl_b32 s43, s43, 3
    v_add_u32 v8, s43, v8
    v_lshrrev_b32 v9, 5, v2
    v_lshl_add_u32 v8, v9, 5, v8
    v_lshlrev_b32 v8, 4, v8
    v_bfe_u32 v9, v2, 4, 1
    v_lshl_add_u32 v8, v9, 3, v8
    s_lshr_b32 s43, s2, 2
    s_lshl_b32 s43, s43, 15
    s_lshl_b32 s44, s3, 12
    s_add_u32 s43, s43, s44
    s_add_u32 s43, s43, 14680064
    v_and_b32 v9, 15, v2
    v_cmp_gt_u32 vcc, 8, v9
    s_and_saveexec_b64 s[40:41], vcc
    buffer_store_dwordx2 v[144:145], v8, s[8:11], s43 offen offset:0
    buffer_store_dwordx2 v[146:147], v8, s[8:11], s43 offen offset:1024
    buffer_store_dwordx2 v[148:149], v8, s[8:11], s43 offen offset:2048
    buffer_store_dwordx2 v[150:151], v8, s[8:11], s43 offen offset:3072
k2_kernel_end:
    s_endpgm
.globl k4_kernel
.p2align 8
.type k4_kernel,@function
k4_kernel:
    s_cmp_ge_u32 s2, 256
    s_cbranch_scc1 k4_kernel_end
    s_load_dwordx4 s[12:15], s[0:1], 48
    s_load_dwordx2 s[18:19], s[0:1], 104
    v_lshrrev_b32 v1, 6, v0
    v_and_b32 v2, 63, v0
    s_and_b32 s20, s2, 1
    s_lshl_b32 s20, s20, 3
    s_bfe_u32 s21, s2, 0x30003
    s_add_u32 s21, s21, s20
    s_bfe_u32 s20, s2, 0x20001
    s_lshl_b32 s20, s20, 2
    s_lshr_b32 s22, s2, 6
    s_add_u32 s20, s20, s22
    v_readfirstlane_b32 s3, v1
    v_lshlrev_b32 v3, 4, v2
    s_waitcnt lgkmcnt(0)
    s_mov_b32 s4, s12
    s_and_b32 s5, s13, 0xffff
    s_mov_b32 s6, 1835008
    s_mov_b32 s7, 0x00020000
    s_mov_b32 s32, s14
    s_and_b32 s33, s15, 0xffff
    s_mov_b32 s34, 1835008
    s_mov_b32 s35, 0x00020000
    s_mov_b32 s8, s18
    s_and_b32 s9, s19, 0xffff
    s_mov_b32 s10, 33554432
    s_mov_b32 s11, 0x00020000
    v_lshrrev_b32 v4, 4, v2
    v_and_b32 v5, 15, v2
    v_mul_u32_u24 v6, 3584, v4
    v_lshlrev_b32 v7, 1, v4
    v_xor_b32 v8, v5, v7
    v_lshl_add_u32 v86, v8, 4, v6
    v_xor_b32 v8, 8, v8
    v_lshl_add_u32 v87, v8, 4, v6
    s_mul_i32 s22, s3, 57344
    s_mul_i32 s23, s20, 224
    s_add_u32 s22, s22, s23
    s_lshl_b32 s23, s3, 12
    s_lshl_b32 s26, s21, 2
    s_add_u32 s26, s26, s3
    s_lshl_b32 s27, s26, 15
    s_add_u32 s27, s27, 14680064
    s_add_u32 s28, s23, 0
    s_mov_b32 m0, s28
    s_add_u32 s29, s22, 0
    buffer_load_dwordx4 v86, s[4:7], s29 offen lds
    s_add_u32 s28, s23, 16384
    s_mov_b32 m0, s28
    s_add_u32 s29, s22, 0
    buffer_load_dwordx4 v87, s[32:35], s29 offen lds
    s_add_u32 s29, s27, 0
    buffer_load_dwordx4 v[128:131], v3, s[8:11], s29 offen offset:0
    s_add_u32 s28, s23, 1024
    s_mov_b32 m0, s28
    s_add_u32 s29, s22, 14336
    buffer_load_dwordx4 v86, s[4:7], s29 offen lds
    s_add_u32 s28, s23, 17408
    s_mov_b32 m0, s28
    s_add_u32 s29, s22, 14336
    buffer_load_dwordx4 v87, s[32:35], s29 offen lds
    s_add_u32 s29, s27, 0
    buffer_load_dwordx4 v[132:135], v3, s[8:11], s29 offen offset:1024
    s_add_u32 s28, s23, 2048
    s_mov_b32 m0, s28
    s_add_u32 s29, s22, 28672
    buffer_load_dwordx4 v86, s[4:7], s29 offen lds
    s_add_u32 s28, s23, 18432
    s_mov_b32 m0, s28
    s_add_u32 s29, s22, 28672
    buffer_load_dwordx4 v87, s[32:35], s29 offen lds
    s_add_u32 s29, s27, 0
    buffer_load_dwordx4 v[136:139], v3, s[8:11], s29 offen offset:2048
    s_add_u32 s28, s23, 3072
    s_mov_b32 m0, s28
    s_add_u32 s29, s22, 43008
    buffer_load_dwordx4 v86, s[4:7], s29 offen lds
    s_add_u32 s28, s23, 19456
    s_mov_b32 m0, s28
    s_add_u32 s29, s22, 43008
    buffer_load_dwordx4 v87, s[32:35], s29 offen lds
    s_add_u32 s29, s27, 0
    buffer_load_dwordx4 v[140:143], v3, s[8:11], s29 offen offset:3072
    s_add_u32 s28, s23, 32768
    s_mov_b32 m0, s28
    s_add_u32 s29, s22, 229376
    buffer_load_dwordx4 v86, s[4:7], s29 offen lds
    s_add_u32 s28, s23, 49152
    s_mov_b32 m0, s28
    s_add_u32 s29, s22, 229376
    buffer_load_dwordx4 v87, s[32:35], s29 offen lds
    s_add_u32 s29, s27, 4096
    buffer_load_dwordx4 v[144:147], v3, s[8:11], s29 offen offset:0
    s_add_u32 s28, s23, 33792
    s_mov_b32 m0, s28
    s_add_u32 s29, s22, 243712
    buffer_load_dwordx4 v86, s[4:7], s29 offen lds
    s_add_u32 s28, s23, 50176
    s_mov_b32 m0, s28
    s_add_u32 s29, s22, 243712
    buffer_load_dwordx4 v87, s[32:35], s29 offen lds
    s_add_u32 s29, s27, 4096
    buffer_load_dwordx4 v[148:151], v3, s[8:11], s29 offen offset:1024
    s_add_u32 s28, s23, 34816
    s_mov_b32 m0, s28
    s_add_u32 s29, s22, 258048
    buffer_load_dwordx4 v86, s[4:7], s29 offen lds
    s_add_u32 s28, s23, 51200
    s_mov_b32 m0, s28
    s_add_u32 s29, s22, 258048
    buffer_load_dwordx4 v87, s[32:35], s29 offen lds
    s_add_u32 s29, s27, 4096
    buffer_load_dwordx4 v[152:155], v3, s[8:11], s29 offen offset:2048
    s_add_u32 s28, s23, 35840
    s_mov_b32 m0, s28
    s_add_u32 s29, s22, 272384
    buffer_load_dwordx4 v86, s[4:7], s29 offen lds
    s_add_u32 s28, s23, 52224
    s_mov_b32 m0, s28
    s_add_u32 s29, s22, 272384
    buffer_load_dwordx4 v87, s[32:35], s29 offen lds
    s_add_u32 s29, s27, 4096
    buffer_load_dwordx4 v[156:159], v3, s[8:11], s29 offen offset:3072
    v_and_b32 v6, 1, v4
    v_lshrrev_b32 v7, 1, v4
    v_lshrrev_b32 v8, 2, v5
    v_lshlrev_b32 v9, 14, v6
    v_lshl_add_u32 v10, v7, 3, v8
    v_lshl_add_u32 v9, v10, 8, v9
    v_and_b32 v10, 3, v5
    v_lshl_add_u32 v9, v10, 3, v9
    v_lshl_add_u32 v10, v6, 2, v8
    v_xor_b32 v11, 0, v10
    v_lshl_add_u32 v72, v11, 5, v9
    v_add_u32 v79, 65536, v72
    v_add_u32 v88, 131072, v72
    v_xor_b32 v11, 1, v10
    v_lshl_add_u32 v73, v11, 5, v9
    v_add_u32 v80, 65536, v73
    v_add_u32 v89, 131072, v73
    v_xor_b32 v11, 2, v10
    v_lshl_add_u32 v74, v11, 5, v9
    v_add_u32 v81, 65536, v74
    v_add_u32 v90, 131072, v74
    v_xor_b32 v11, 3, v10
    v_lshl_add_u32 v75, v11, 5, v9
    v_add_u32 v82, 65536, v75
    v_add_u32 v91, 131072, v75
    v_xor_b32 v11, 4, v10
    v_lshl_add_u32 v76, v11, 5, v9
    v_add_u32 v83, 65536, v76
    v_add_u32 v92, 131072, v76
    v_xor_b32 v11, 5, v10
    v_lshl_add_u32 v77, v11, 5, v9
    v_add_u32 v84, 65536, v77
    v_add_u32 v93, 131072, v77
    v_xor_b32 v11, 6, v10
    v_lshl_add_u32 v78, v11, 5, v9
    v_add_u32 v85, 65536, v78
    v_add_u32 v94, 131072, v78
    s_waitcnt vmcnt(12)
    s_barrier
    ds_read_b64_tr_b16 v[16:17], v72 offset:0
    ds_read_b64_tr_b16 v[18:19], v72 offset:1024
    ds_read_b64_tr_b16 v[20:21], v73 offset:0
    ds_read_b64_tr_b16 v[22:23], v73 offset:1024
    ds_read_b64_tr_b16 v[24:25], v74 offset:0
    ds_read_b64_tr_b16 v[26:27], v74 offset:1024
    ds_read_b64_tr_b16 v[28:29], v75 offset:0
    ds_read_b64_tr_b16 v[30:31], v75 offset:1024
    ds_read_b64_tr_b16 v[32:33], v76 offset:0
    ds_read_b64_tr_b16 v[34:35], v76 offset:1024
    ds_read_b64_tr_b16 v[36:37], v77 offset:0
    ds_read_b64_tr_b16 v[38:39], v77 offset:1024
    ds_read_b64_tr_b16 v[40:41], v78 offset:0
    ds_read_b64_tr_b16 v[42:43], v78 offset:1024
    s_waitcnt lgkmcnt(12)
    v_mfma_f32_32x32x16_bf16 a[0:15], v[16:19], v[128:131], 0
    ds_read_b64_tr_b16 v[44:45], v72 offset:4096
    ds_read_b64_tr_b16 v[46:47], v72 offset:5120
    s_add_u32 s28, s23, 65536
    s_mov_b32 m0, s28
    s_add_u32 s29, s22, 458752
    buffer_load_dwordx4 v86, s[4:7], s29 offen lds
    s_waitcnt lgkmcnt(12)
    v_mfma_f32_32x32x16_bf16 a[16:31], v[20:23], v[128:131], 0
    ds_read_b64_tr_b16 v[48:49], v73 offset:4096
    ds_read_b64_tr_b16 v[50:51], v73 offset:5120
    s_add_u32 s28, s23, 81920
    s_mov_b32 m0, s28
    s_add_u32 s29, s22, 458752
    buffer_load_dwordx4 v87, s[32:35], s29 offen lds
    s_waitcnt lgkmcnt(12)
    v_mfma_f32_32x32x16_bf16 a[32:47], v[24:27], v[128:131], 0
    ds_read_b64_tr_b16 v[52:53], v74 offset:4096
    ds_read_b64_tr_b16 v[54:55], v74 offset:5120
    s_add_u32 s29, s27, 8192
    buffer_load_dwordx4 v[160:163], v3, s[8:11], s29 offen offset:0
    s_waitcnt lgkmcnt(12)
    v_mfma_f32_32x32x16_bf16 a[48:63], v[28:31], v[128:131], 0
    ds_read_b64_tr_b16 v[56:57], v75 offset:4096
    ds_read_b64_tr_b16 v[58:59], v75 offset:5120
    s_add_u32 s28, s23, 66560
    s_mov_b32 m0, s28
    s_add_u32 s29, s22, 473088
    buffer_load_dwordx4 v86, s[4:7], s29 offen lds
    s_waitcnt lgkmcnt(12)
    v_mfma_f32_32x32x16_bf16 a[64:79], v[32:35], v[128:131], 0
    ds_read_b64_tr_b16 v[60:61], v76 offset:4096
    ds_read_b64_tr_b16 v[62:63], v76 offset:5120
    s_add_u32 s28, s23, 82944
    s_mov_b32 m0, s28
    s_add_u32 s29, s22, 473088
    buffer_load_dwordx4 v87, s[32:35], s29 offen lds
    s_waitcnt lgkmcnt(12)
    v_mfma_f32_32x32x16_bf16 a[80:95], v[36:39], v[128:131], 0
    ds_read_b64_tr_b16 v[64:65], v77 offset:4096
    ds_read_b64_tr_b16 v[66:67], v77 offset:5120
    s_add_u32 s29, s27, 8192
    buffer_load_dwordx4 v[164:167], v3, s[8:11], s29 offen offset:1024
    s_waitcnt lgkmcnt(12)
    v_mfma_f32_32x32x16_bf16 a[96:111], v[40:43], v[128:131], 0
    ds_read_b64_tr_b16 v[68:69], v78 offset:4096
    ds_read_b64_tr_b16 v[70:71], v78 offset:5120
    s_add_u32 s28, s23, 67584
    s_mov_b32 m0, s28
    s_add_u32 s29, s22, 487424
    buffer_load_dwordx4 v86, s[4:7], s29 offen lds
    s_waitcnt lgkmcnt(12)
    v_mfma_f32_32x32x16_bf16 a[0:15], v[44:47], v[132:135], a[0:15]
    ds_read_b64_tr_b16 v[16:17], v72 offset:8192
    ds_read_b64_tr_b16 v[18:19], v72 offset:9216
    s_add_u32 s28, s23, 83968
    s_mov_b32 m0, s28
    s_add_u32 s29, s22, 487424
    buffer_load_dwordx4 v87, s[32:35], s29 offen lds
    s_waitcnt lgkmcnt(12)
    v_mfma_f32_32x32x16_bf16 a[16:31], v[48:51], v[132:135], a[16:31]
    ds_read_b64_tr_b16 v[20:21], v73 offset:8192
    ds_read_b64_tr_b16 v[22:23], v73 offset:9216
    s_add_u32 s29, s27, 8192
    buffer_load_dwordx4 v[168:171], v3, s[8:11], s29 offen offset:2048
    s_waitcnt lgkmcnt(12)
    v_mfma_f32_32x32x16_bf16 a[32:47], v[52:55], v[132:135], a[32:47]
    ds_read_b64_tr_b16 v[24:25], v74 offset:8192
    ds_read_b64_tr_b16 v[26:27], v74 offset:9216
    s_add_u32 s28, s23, 68608
    s_mov_b32 m0, s28
    s_add_u32 s29, s22, 501760
    buffer_load_dwordx4 v86, s[4:7], s29 offen lds
    s_waitcnt lgkmcnt(12)
    v_mfma_f32_32x32x16_bf16 a[48:63], v[56:59], v[132:135], a[48:63]
    ds_read_b64_tr_b16 v[28:29], v75 offset:8192
    ds_read_b64_tr_b16 v[30:31], v75 offset:9216
    s_add_u32 s28, s23, 84992
    s_mov_b32 m0, s28
    s_add_u32 s29, s22, 501760
    buffer_load_dwordx4 v87, s[32:35], s29 offen lds
    s_waitcnt lgkmcnt(12)
    v_mfma_f32_32x32x16_bf16 a[64:79], v[60:63], v[132:135], a[64:79]
    ds_read_b64_tr_b16 v[32:33], v76 offset:8192
    ds_read_b64_tr_b16 v[34:35], v76 offset:9216
    s_add_u32 s29, s27, 8192
    buffer_load_dwordx4 v[172:175], v3, s[8:11], s29 offen offset:3072
    s_waitcnt lgkmcnt(12)
    v_mfma_f32_32x32x16_bf16 a[80:95], v[64:67], v[132:135], a[80:95]
    ds_read_b64_tr_b16 v[36:37], v77 offset:8192
    ds_read_b64_tr_b16 v[38:39], v77 offset:9216
    s_add_u32 s28, s23, 98304
    s_mov_b32 m0, s28
    s_add_u32 s29, s22, 688128
    buffer_load_dwordx4 v86, s[4:7], s29 offen lds
    s_waitcnt lgkmcnt(12)
    v_mfma_f32_32x32x16_bf16 a[96:111], v[68:71], v[132:135], a[96:111]
    ds_read_b64_tr_b16 v[40:41], v78 offset:8192
    ds_read_b64_tr_b16 v[42:43], v78 offset:9216
    s_add_u32 s28, s23, 114688
    s_mov_b32 m0, s28
    s_add_u32 s29, s22, 688128
    buffer_load_dwordx4 v87, s[32:35], s29 offen lds
    s_waitcnt lgkmcnt(12)
    v_mfma_f32_32x32x16_bf16 a[0:15], v[16:19], v[136:139], a[0:15]
    ds_read_b64_tr_b16 v[44:45], v72 offset:12288
    ds_read_b64_tr_b16 v[46:47], v72 offset:13312
    s_add_u32 s29, s27, 12288
    buffer_load_dwordx4 v[176:179], v3, s[8:11], s29 offen offset:0
    s_waitcnt lgkmcnt(12)
    v_mfma_f32_32x32x16_bf16 a[16:31], v[20:23], v[136:139], a[16:31]
    ds_read_b64_tr_b16 v[48:49], v73 offset:12288
    ds_read_b64_tr_b16 v[50:51], v73 offset:13312
    s_add_u32 s28, s23, 99328
    s_mov_b32 m0, s28
    s_add_u32 s29, s22, 702464
    buffer_load_dwordx4 v86, s[4:7], s29 offen lds
    s_waitcnt lgkmcnt(12)
    v_mfma_f32_32x32x16_bf16 a[32:47], v[24:27], v[136:139], a[32:47]
    ds_read_b64_tr_b16 v[52:53], v74 offset:12288
    ds_read_b64_tr_b16 v[54:55], v74 offset:13312
    s_add_u32 s28, s23, 115712
    s_mov_b32 m0, s28
    s_add_u32 s29, s22, 702464
    buffer_load_dwordx4 v87, s[32:35], s29 offen lds
    s_waitcnt lgkmcnt(12)
    v_mfma_f32_32x32x16_bf16 a[48:63], v[28:31], v[136:139], a[48:63]
    ds_read_b64_tr_b16 v[56:57], v75 offset:12288
    ds_read_b64_tr_b16 v[58:59], v75 offset:13312
    s_add_u32 s29, s27, 12288
    buffer_load_dwordx4 v[180:183], v3, s[8:11], s29 offen offset:1024
    s_waitcnt lgkmcnt(12)
    v_mfma_f32_32x32x16_bf16 a[64:79], v[32:35], v[136:139], a[64:79]
    ds_read_b64_tr_b16 v[60:61], v76 offset:12288
    ds_read_b64_tr_b16 v[62:63], v76 offset:13312
    s_add_u32 s28, s23, 100352
    s_mov_b32 m0, s28
    s_add_u32 s29, s22, 716800
    buffer_load_dwordx4 v86, s[4:7], s29 offen lds
    s_waitcnt lgkmcnt(12)
    v_mfma_f32_32x32x16_bf16 a[80:95], v[36:39], v[136:139], a[80:95]
    ds_read_b64_tr_b16 v[64:65], v77 offset:12288
    ds_read_b64_tr_b16 v[66:67], v77 offset:13312
    s_add_u32 s28, s23, 116736
    s_mov_b32 m0, s28
    s_add_u32 s29, s22, 716800
    buffer_load_dwordx4 v87, s[32:35], s29 offen lds
    s_waitcnt lgkmcnt(12)
    v_mfma_f32_32x32x16_bf16 a[96:111], v[40:43], v[136:139], a[96:111]
    ds_read_b64_tr_b16 v[68:69], v78 offset:12288
    ds_read_b64_tr_b16 v[70:71], v78 offset:13312
    s_add_u32 s29, s27, 12288
    buffer_load_dwordx4 v[184:187], v3, s[8:11], s29 offen offset:2048
    s_waitcnt vmcnt(21)
    s_barrier
    s_waitcnt lgkmcnt(12)
    v_mfma_f32_32x32x16_bf16 a[0:15], v[44:47], v[140:143], a[0:15]
    ds_read_b64_tr_b16 v[16:17], v72 offset:32768
    ds_read_b64_tr_b16 v[18:19], v72 offset:33792
    s_add_u32 s28, s23, 101376
    s_mov_b32 m0, s28
    s_add_u32 s29, s22, 731136
    buffer_load_dwordx4 v86, s[4:7], s29 offen lds
    s_waitcnt lgkmcnt(12)
    v_mfma_f32_32x32x16_bf16 a[16:31], v[48:51], v[140:143], a[16:31]
    ds_read_b64_tr_b16 v[20:21], v73 offset:32768
    ds_read_b64_tr_b16 v[22:23], v73 offset:33792
    s_add_u32 s28, s23, 117760
    s_mov_b32 m0, s28
    s_add_u32 s29, s22, 731136
    buffer_load_dwordx4 v87, s[32:35], s29 offen lds
    s_waitcnt lgkmcnt(12)
    v_mfma_f32_32x32x16_bf16 a[32:47], v[52:55], v[140:143], a[32:47]
    ds_read_b64_tr_b16 v[24:25], v74 offset:32768
    ds_read_b64_tr_b16 v[26:27], v74 offset:33792
    s_add_u32 s29, s27, 12288
    buffer_load_dwordx4 v[188:191], v3, s[8:11], s29 offen offset:3072
    s_waitcnt lgkmcnt(12)
    v_mfma_f32_32x32x16_bf16 a[48:63], v[56:59], v[140:143], a[48:63]
    ds_read_b64_tr_b16 v[28:29], v75 offset:32768
    ds_read_b64_tr_b16 v[30:31], v75 offset:33792
    s_add_u32 s28, s23, 131072
    s_mov_b32 m0, s28
    s_add_u32 s29, s22, 917504
    buffer_load_dwordx4 v86, s[4:7], s29 offen lds
    s_waitcnt lgkmcnt(12)
    v_mfma_f32_32x32x16_bf16 a[64:79], v[60:63], v[140:143], a[64:79]
    ds_read_b64_tr_b16 v[32:33], v76 offset:32768
    ds_read_b64_tr_b16 v[34:35], v76 offset:33792
    s_add_u32 s28, s23, 147456
    s_mov_b32 m0, s28
    s_add_u32 s29, s22, 917504
    buffer_load_dwordx4 v87, s[32:35], s29 offen lds
    s_waitcnt lgkmcnt(12)
    v_mfma_f32_32x32x16_bf16 a[80:95], v[64:67], v[140:143], a[80:95]
    ds_read_b64_tr_b16 v[36:37], v77 offset:32768
    ds_read_b64_tr_b16 v[38:39], v77 offset:33792
    s_add_u32 s29, s27, 16384
    buffer_load_dwordx4 v[192:195], v3, s[8:11], s29 offen offset:0
    s_waitcnt lgkmcnt(12)
    v_mfma_f32_32x32x16_bf16 a[96:111], v[68:71], v[140:143], a[96:111]
    ds_read_b64_tr_b16 v[40:41], v78 offset:32768
    ds_read_b64_tr_b16 v[42:43], v78 offset:33792
    s_add_u32 s28, s23, 132096
    s_mov_b32 m0, s28
    s_add_u32 s29, s22, 931840
    buffer_load_dwordx4 v86, s[4:7], s29 offen lds
    s_waitcnt lgkmcnt(12)
    v_mfma_f32_32x32x16_bf16 a[0:15], v[16:19], v[144:147], a[0:15]
    ds_read_b64_tr_b16 v[44:45], v72 offset:36864
    ds_read_b64_tr_b16 v[46:47], v72 offset:37888
    s_add_u32 s28, s23, 148480
    s_mov_b32 m0, s28
    s_add_u32 s29, s22, 931840
    buffer_load_dwordx4 v87, s[32:35], s29 offen lds
    s_waitcnt lgkmcnt(12)
    v_mfma_f32_32x32x16_bf16 a[16:31], v[20:23], v[144:147], a[16:31]
    ds_read_b64_tr_b16 v[48:49], v73 offset:36864
    ds_read_b64_tr_b16 v[50:51], v73 offset:37888
    s_add_u32 s29, s27, 16384
    buffer_load_dwordx4 v[196:199], v3, s[8:11], s29 offen offset:1024
    s_waitcnt lgkmcnt(12)
    v_mfma_f32_32x32x16_bf16 a[32:47], v[24:27], v[144:147], a[32:47]
    ds_read_b64_tr_b16 v[52:53], v74 offset:36864
    ds_read_b64_tr_b16 v[54:55], v74 offset:37888
    s_add_u32 s28, s23, 133120
    s_mov_b32 m0, s28
    s_add_u32 s29, s22, 946176
    buffer_load_dwordx4 v86, s[4:7], s29 offen lds
    s_waitcnt lgkmcnt(12)
    v_mfma_f32_32x32x16_bf16 a[48:63], v[28:31], v[144:147], a[48:63]
    ds_read_b64_tr_b16 v[56:57], v75 offset:36864
    ds_read_b64_tr_b16 v[58:59], v75 offset:37888
    s_add_u32 s28, s23, 149504
    s_mov_b32 m0, s28
    s_add_u32 s29, s22, 946176
    buffer_load_dwordx4 v87, s[32:35], s29 offen lds
    s_waitcnt lgkmcnt(12)
    v_mfma_f32_32x32x16_bf16 a[64:79], v[32:35], v[144:147], a[64:79]
    ds_read_b64_tr_b16 v[60:61], v76 offset:36864
    ds_read_b64_tr_b16 v[62:63], v76 offset:37888
    s_add_u32 s29, s27, 16384
    buffer_load_dwordx4 v[200:203], v3, s[8:11], s29 offen offset:2048
    s_waitcnt lgkmcnt(12)
    v_mfma_f32_32x32x16_bf16 a[80:95], v[36:39], v[144:147], a[80:95]
    ds_read_b64_tr_b16 v[64:65], v77 offset:36864
    ds_read_b64_tr_b16 v[66:67], v77 offset:37888
    s_add_u32 s28, s23, 134144
    s_mov_b32 m0, s28
    s_add_u32 s29, s22, 960512
    buffer_load_dwordx4 v86, s[4:7], s29 offen lds
    s_waitcnt lgkmcnt(12)
    v_mfma_f32_32x32x16_bf16 a[96:111], v[40:43], v[144:147], a[96:111]
    ds_read_b64_tr_b16 v[68:69], v78 offset:36864
    ds_read_b64_tr_b16 v[70:71], v78 offset:37888
    s_add_u32 s28, s23, 150528
    s_mov_b32 m0, s28
    s_add_u32 s29, s22, 960512
    buffer_load_dwordx4 v87, s[32:35], s29 offen lds
    s_waitcnt lgkmcnt(12)
    v_mfma_f32_32x32x16_bf16 a[0:15], v[44:47], v[148:151], a[0:15]
    ds_read_b64_tr_b16 v[16:17], v72 offset:40960
    ds_read_b64_tr_b16 v[18:19], v72 offset:41984
    s_add_u32 s29, s27, 16384
    buffer_load_dwordx4 v[204:207], v3, s[8:11], s29 offen offset:3072
    s_waitcnt lgkmcnt(12)
    v_mfma_f32_32x32x16_bf16 a[16:31], v[48:51], v[148:151], a[16:31]
    ds_read_b64_tr_b16 v[20:21], v73 offset:40960
    ds_read_b64_tr_b16 v[22:23], v73 offset:41984
    s_waitcnt lgkmcnt(12)
    v_mfma_f32_32x32x16_bf16 a[32:47], v[52:55], v[148:151], a[32:47]
    ds_read_b64_tr_b16 v[24:25], v74 offset:40960
    ds_read_b64_tr_b16 v[26:27], v74 offset:41984
    s_waitcnt lgkmcnt(12)
    v_mfma_f32_32x32x16_bf16 a[48:63], v[56:59], v[148:151], a[48:63]
    ds_read_b64_tr_b16 v[28:29], v75 offset:40960
    ds_read_b64_tr_b16 v[30:31], v75 offset:41984
    s_waitcnt lgkmcnt(12)
    v_mfma_f32_32x32x16_bf16 a[64:79], v[60:63], v[148:151], a[64:79]
    ds_read_b64_tr_b16 v[32:33], v76 offset:40960
    ds_read_b64_tr_b16 v[34:35], v76 offset:41984
    s_waitcnt lgkmcnt(12)
    v_mfma_f32_32x32x16_bf16 a[80:95], v[64:67], v[148:151], a[80:95]
    ds_read_b64_tr_b16 v[36:37], v77 offset:40960
    ds_read_b64_tr_b16 v[38:39], v77 offset:41984
    s_waitcnt lgkmcnt(12)
    v_mfma_f32_32x32x16_bf16 a[96:111], v[68:71], v[148:151], a[96:111]
    ds_read_b64_tr_b16 v[40:41], v78 offset:40960
    ds_read_b64_tr_b16 v[42:43], v78 offset:41984
    s_waitcnt lgkmcnt(12)
    v_mfma_f32_32x32x16_bf16 a[0:15], v[16:19], v[152:155], a[0:15]
    ds_read_b64_tr_b16 v[44:45], v72 offset:45056
    ds_read_b64_tr_b16 v[46:47], v72 offset:46080
    s_waitcnt lgkmcnt(12)
    v_mfma_f32_32x32x16_bf16 a[16:31], v[20:23], v[152:155], a[16:31]
    ds_read_b64_tr_b16 v[48:49], v73 offset:45056
    ds_read_b64_tr_b16 v[50:51], v73 offset:46080
    s_waitcnt lgkmcnt(12)
    v_mfma_f32_32x32x16_bf16 a[32:47], v[24:27], v[152:155], a[32:47]
    ds_read_b64_tr_b16 v[52:53], v74 offset:45056
    ds_read_b64_tr_b16 v[54:55], v74 offset:46080
    s_waitcnt lgkmcnt(12)
    v_mfma_f32_32x32x16_bf16 a[48:63], v[28:31], v[152:155], a[48:63]
    ds_read_b64_tr_b16 v[56:57], v75 offset:45056
    ds_read_b64_tr_b16 v[58:59], v75 offset:46080
    s_waitcnt lgkmcnt(12)
    v_mfma_f32_32x32x16_bf16 a[64:79], v[32:35], v[152:155], a[64:79]
    ds_read_b64_tr_b16 v[60:61], v76 offset:45056
    ds_read_b64_tr_b16 v[62:63], v76 offset:46080
    s_waitcnt lgkmcnt(12)
    v_mfma_f32_32x32x16_bf16 a[80:95], v[36:39], v[152:155], a[80:95]
    ds_read_b64_tr_b16 v[64:65], v77 offset:45056
    ds_read_b64_tr_b16 v[66:67], v77 offset:46080
    s_waitcnt lgkmcnt(12)
    v_mfma_f32_32x32x16_bf16 a[96:111], v[40:43], v[152:155], a[96:111]
    ds_read_b64_tr_b16 v[68:69], v78 offset:45056
    ds_read_b64_tr_b16 v[70:71], v78 offset:46080
    s_waitcnt vmcnt(24)
    s_barrier
    s_waitcnt lgkmcnt(12)
    v_mfma_f32_32x32x16_bf16 a[0:15], v[44:47], v[156:159], a[0:15]
    ds_read_b64_tr_b16 v[16:17], v79 offset:0
    ds_read_b64_tr_b16 v[18:19], v79 offset:1024
    s_add_u32 s28, s23, 0
    s_mov_b32 m0, s28
    s_add_u32 s29, s22, 1146880
    buffer_load_dwordx4 v86, s[4:7], s29 offen lds
    s_waitcnt lgkmcnt(12)
    v_mfma_f32_32x32x16_bf16 a[16:31], v[48:51], v[156:159], a[16:31]
    ds_read_b64_tr_b16 v[20:21], v80 offset:0
    ds_read_b64_tr_b16 v[22:23], v80 offset:1024
    s_add_u32 s28, s23, 16384
    s_mov_b32 m0, s28
    s_add_u32 s29, s22, 1146880
    buffer_load_dwordx4 v87, s[32:35], s29 offen lds
    s_waitcnt lgkmcnt(12)
    v_mfma_f32_32x32x16_bf16 a[32:47], v[52:55], v[156:159], a[32:47]
    ds_read_b64_tr_b16 v[24:25], v81 offset:0
    ds_read_b64_tr_b16 v[26:27], v81 offset:1024
    s_add_u32 s29, s27, 20480
    buffer_load_dwordx4 v[208:211], v3, s[8:11], s29 offen offset:0
    s_waitcnt lgkmcnt(12)
    v_mfma_f32_32x32x16_bf16 a[48:63], v[56:59], v[156:159], a[48:63]
    ds_read_b64_tr_b16 v[28:29], v82 offset:0
    ds_read_b64_tr_b16 v[30:31], v82 offset:1024
    s_add_u32 s28, s23, 1024
    s_mov_b32 m0, s28
    s_add_u32 s29, s22, 1161216
    buffer_load_dwordx4 v86, s[4:7], s29 offen lds
    s_waitcnt lgkmcnt(12)
    v_mfma_f32_32x32x16_bf16 a[64:79], v[60:63], v[156:159], a[64:79]
    ds_read_b64_tr_b16 v[32:33], v83 offset:0
    ds_read_b64_tr_b16 v[34:35], v83 offset:1024
    s_add_u32 s28, s23, 17408
    s_mov_b32 m0, s28
    s_add_u32 s29, s22, 1161216
    buffer_load_dwordx4 v87, s[32:35], s29 offen lds
    s_waitcnt lgkmcnt(12)
    v_mfma_f32_32x32x16_bf16 a[80:95], v[64:67], v[156:159], a[80:95]
    ds_read_b64_tr_b16 v[36:37], v84 offset:0
    ds_read_b64_tr_b16 v[38:39], v84 offset:1024
    s_add_u32 s29, s27, 20480
    buffer_load_dwordx4 v[212:215], v3, s[8:11], s29 offen offset:1024
    s_waitcnt lgkmcnt(12)
    v_mfma_f32_32x32x16_bf16 a[96:111], v[68:71], v[156:159], a[96:111]
    ds_read_b64_tr_b16 v[40:41], v85 offset:0
    ds_read_b64_tr_b16 v[42:43], v85 offset:1024
    s_add_u32 s28, s23, 2048
    s_mov_b32 m0, s28
    s_add_u32 s29, s22, 1175552
    buffer_load_dwordx4 v86, s[4:7], s29 offen lds
    s_waitcnt lgkmcnt(12)
    v_mfma_f32_32x32x16_bf16 a[0:15], v[16:19], v[160:163], a[0:15]
    ds_read_b64_tr_b16 v[44:45], v79 offset:4096
    ds_read_b64_tr_b16 v[46:47], v79 offset:5120
    s_add_u32 s28, s23, 18432
    s_mov_b32 m0, s28
    s_add_u32 s29, s22, 1175552
    buffer_load_dwordx4 v87, s[32:35], s29 offen lds
    s_waitcnt lgkmcnt(12)
    v_mfma_f32_32x32x16_bf16 a[16:31], v[20:23], v[160:163], a[16:31]
    ds_read_b64_tr_b16 v[48:49], v80 offset:4096
    ds_read_b64_tr_b16 v[50:51], v80 offset:5120
    s_waitcnt lgkmcnt(12)
    v_mfma_f32_32x32x16_bf16 a[32:47], v[24:27], v[160:163], a[32:47]
    ds_read_b64_tr_b16 v[52:53], v81 offset:4096
    ds_read_b64_tr_b16 v[54:55], v81 offset:5120
    s_add_u32 s29, s27, 20480
    buffer_load_dwordx4 v[216:219], v3, s[8:11], s29 offen offset:2048
    s_waitcnt lgkmcnt(12)
    v_mfma_f32_32x32x16_bf16 a[48:63], v[28:31], v[160:163], a[48:63]
    ds_read_b64_tr_b16 v[56:57], v82 offset:4096
    ds_read_b64_tr_b16 v[58:59], v82 offset:5120
    s_waitcnt lgkmcnt(12)
    v_mfma_f32_32x32x16_bf16 a[64:79], v[32:35], v[160:163], a[64:79]
    ds_read_b64_tr_b16 v[60:61], v83 offset:4096
    ds_read_b64_tr_b16 v[62:63], v83 offset:5120
    s_add_u32 s28, s23, 3072
    s_mov_b32 m0, s28
    s_add_u32 s29, s22, 1189888
    buffer_load_dwordx4 v86, s[4:7], s29 offen lds
    s_waitcnt lgkmcnt(12)
    v_mfma_f32_32x32x16_bf16 a[80:95], v[36:39], v[160:163], a[80:95]
    ds_read_b64_tr_b16 v[64:65], v84 offset:4096
    ds_read_b64_tr_b16 v[66:67], v84 offset:5120
    s_waitcnt lgkmcnt(12)
    v_mfma_f32_32x32x16_bf16 a[96:111], v[40:43], v[160:163], a[96:111]
    ds_read_b64_tr_b16 v[68:69], v85 offset:4096
    ds_read_b64_tr_b16 v[70:71], v85 offset:5120
    s_add_u32 s28, s23, 19456
    s_mov_b32 m0, s28
    s_add_u32 s29, s22, 1189888
    buffer_load_dwordx4 v87, s[32:35], s29 offen lds
    s_waitcnt lgkmcnt(12)
    v_mfma_f32_32x32x16_bf16 a[0:15], v[44:47], v[164:167], a[0:15]
    ds_read_b64_tr_b16 v[16:17], v79 offset:8192
    ds_read_b64_tr_b16 v[18:19], v79 offset:9216
    s_add_u32 s29, s27, 20480
    buffer_load_dwordx4 v[220:223], v3, s[8:11], s29 offen offset:3072
    s_waitcnt lgkmcnt(12)
    v_mfma_f32_32x32x16_bf16 a[16:31], v[48:51], v[164:167], a[16:31]
    ds_read_b64_tr_b16 v[20:21], v80 offset:8192
    ds_read_b64_tr_b16 v[22:23], v80 offset:9216
    s_waitcnt lgkmcnt(12)
    v_mfma_f32_32x32x16_bf16 a[32:47], v[52:55], v[164:167], a[32:47]
    ds_read_b64_tr_b16 v[24:25], v81 offset:8192
    ds_read_b64_tr_b16 v[26:27], v81 offset:9216
    s_waitcnt lgkmcnt(12)
    v_mfma_f32_32x32x16_bf16 a[48:63], v[56:59], v[164:167], a[48:63]
    ds_read_b64_tr_b16 v[28:29], v82 offset:8192
    ds_read_b64_tr_b16 v[30:31], v82 offset:9216
    s_waitcnt lgkmcnt(12)
    v_mfma_f32_32x32x16_bf16 a[64:79], v[60:63], v[164:167], a[64:79]
    ds_read_b64_tr_b16 v[32:33], v83 offset:8192
    ds_read_b64_tr_b16 v[34:35], v83 offset:9216
    s_waitcnt lgkmcnt(12)
    v_mfma_f32_32x32x16_bf16 a[80:95], v[64:67], v[164:167], a[80:95]
    ds_read_b64_tr_b16 v[36:37], v84 offset:8192
    ds_read_b64_tr_b16 v[38:39], v84 offset:9216
    s_waitcnt lgkmcnt(12)
    v_mfma_f32_32x32x16_bf16 a[96:111], v[68:71], v[164:167], a[96:111]
    ds_read_b64_tr_b16 v[40:41], v85 offset:8192
    ds_read_b64_tr_b16 v[42:43], v85 offset:9216
    s_waitcnt lgkmcnt(12)
    v_mfma_f32_32x32x16_bf16 a[0:15], v[16:19], v[168:171], a[0:15]
    ds_read_b64_tr_b16 v[44:45], v79 offset:12288
    ds_read_b64_tr_b16 v[46:47], v79 offset:13312
    s_waitcnt lgkmcnt(12)
    v_mfma_f32_32x32x16_bf16 a[16:31], v[20:23], v[168:171], a[16:31]
    ds_read_b64_tr_b16 v[48:49], v80 offset:12288
    ds_read_b64_tr_b16 v[50:51], v80 offset:13312
    s_waitcnt lgkmcnt(12)
    v_mfma_f32_32x32x16_bf16 a[32:47], v[24:27], v[168:171], a[32:47]
    ds_read_b64_tr_b16 v[52:53], v81 offset:12288
    ds_read_b64_tr_b16 v[54:55], v81 offset:13312
    s_waitcnt lgkmcnt(12)
    v_mfma_f32_32x32x16_bf16 a[48:63], v[28:31], v[168:171], a[48:63]
    ds_read_b64_tr_b16 v[56:57], v82 offset:12288
    ds_read_b64_tr_b16 v[58:59], v82 offset:13312
    s_waitcnt lgkmcnt(12)
    v_mfma_f32_32x32x16_bf16 a[64:79], v[32:35], v[168:171], a[64:79]
    ds_read_b64_tr_b16 v[60:61], v83 offset:12288
    ds_read_b64_tr_b16 v[62:63], v83 offset:13312
    s_waitcnt lgkmcnt(12)
    v_mfma_f32_32x32x16_bf16 a[80:95], v[36:39], v[168:171], a[80:95]
    ds_read_b64_tr_b16 v[64:65], v84 offset:12288
    ds_read_b64_tr_b16 v[66:67], v84 offset:13312
    s_waitcnt lgkmcnt(12)
    v_mfma_f32_32x32x16_bf16 a[96:111], v[40:43], v[168:171], a[96:111]
    ds_read_b64_tr_b16 v[68:69], v85 offset:12288
    ds_read_b64_tr_b16 v[70:71], v85 offset:13312
    s_waitcnt vmcnt(24)
    s_barrier
    s_waitcnt lgkmcnt(12)
    v_mfma_f32_32x32x16_bf16 a[0:15], v[44:47], v[172:175], a[0:15]
    ds_read_b64_tr_b16 v[16:17], v79 offset:32768
    ds_read_b64_tr_b16 v[18:19], v79 offset:33792
    s_add_u32 s28, s23, 32768
    s_mov_b32 m0, s28
    s_add_u32 s29, s22, 1376256
    buffer_load_dwordx4 v86, s[4:7], s29 offen lds
    s_waitcnt lgkmcnt(12)
    v_mfma_f32_32x32x16_bf16 a[16:31], v[48:51], v[172:175], a[16:31]
    ds_read_b64_tr_b16 v[20:21], v80 offset:32768
    ds_read_b64_tr_b16 v[22:23], v80 offset:33792
    s_waitcnt lgkmcnt(12)
    v_mfma_f32_32x32x16_bf16 a[32:47], v[52:55], v[172:175], a[32:47]
    ds_read_b64_tr_b16 v[24:25], v81 offset:32768
    ds_read_b64_tr_b16 v[26:27], v81 offset:33792
    s_add_u32 s28, s23, 49152
    s_mov_b32 m0, s28
    s_add_u32 s29, s22, 1376256
    buffer_load_dwordx4 v87, s[32:35], s29 offen lds
    s_waitcnt lgkmcnt(12)
    v_mfma_f32_32x32x16_bf16 a[48:63], v[56:59], v[172:175], a[48:63]
    ds_read_b64_tr_b16 v[28:29], v82 offset:32768
    ds_read_b64_tr_b16 v[30:31], v82 offset:33792
    s_waitcnt lgkmcnt(12)
    v_mfma_f32_32x32x16_bf16 a[64:79], v[60:63], v[172:175], a[64:79]
    ds_read_b64_tr_b16 v[32:33], v83 offset:32768
    ds_read_b64_tr_b16 v[34:35], v83 offset:33792
    s_add_u32 s29, s27, 24576
    buffer_load_dwordx4 v[224:227], v3, s[8:11], s29 offen offset:0
    s_waitcnt lgkmcnt(12)
    v_mfma_f32_32x32x16_bf16 a[80:95], v[64:67], v[172:175], a[80:95]
    ds_read_b64_tr_b16 v[36:37], v84 offset:32768
    ds_read_b64_tr_b16 v[38:39], v84 offset:33792
    s_waitcnt lgkmcnt(12)
    v_mfma_f32_32x32x16_bf16 a[96:111], v[68:71], v[172:175], a[96:111]
    ds_read_b64_tr_b16 v[40:41], v85 offset:32768
    ds_read_b64_tr_b16 v[42:43], v85 offset:33792
    s_add_u32 s28, s23, 33792
    s_mov_b32 m0, s28
    s_add_u32 s29, s22, 1390592
    buffer_load_dwordx4 v86, s[4:7], s29 offen lds
    s_waitcnt lgkmcnt(12)
    v_mfma_f32_32x32x16_bf16 a[0:15], v[16:19], v[176:179], a[0:15]
    ds_read_b64_tr_b16 v[44:45], v79 offset:36864
    ds_read_b64_tr_b16 v[46:47], v79 offset:37888
    s_add_u32 s28, s23, 50176
    s_mov_b32 m0, s28
    s_add_u32 s29, s22, 1390592
    buffer_load_dwordx4 v87, s[32:35], s29 offen lds
    s_waitcnt lgkmcnt(12)
    v_mfma_f32_32x32x16_bf16 a[16:31], v[20:23], v[176:179], a[16:31]
    ds_read_b64_tr_b16 v[48:49], v80 offset:36864
    ds_read_b64_tr_b16 v[50:51], v80 offset:37888
    s_waitcnt lgkmcnt(12)
    v_mfma_f32_32x32x16_bf16 a[32:47], v[24:27], v[176:179], a[32:47]
    ds_read_b64_tr_b16 v[52:53], v81 offset:36864
    ds_read_b64_tr_b16 v[54:55], v81 offset:37888
    s_add_u32 s29, s27, 24576
    buffer_load_dwordx4 v[228:231], v3, s[8:11], s29 offen offset:1024
    s_waitcnt lgkmcnt(12)
    v_mfma_f32_32x32x16_bf16 a[48:63], v[28:31], v[176:179], a[48:63]
    ds_read_b64_tr_b16 v[56:57], v82 offset:36864
    ds_read_b64_tr_b16 v[58:59], v82 offset:37888
    s_waitcnt lgkmcnt(12)
    v_mfma_f32_32x32x16_bf16 a[64:79], v[32:35], v[176:179], a[64:79]
    ds_read_b64_tr_b16 v[60:61], v83 offset:36864
    ds_read_b64_tr_b16 v[62:63], v83 offset:37888
    s_add_u32 s28, s23, 34816
    s_mov_b32 m0, s28
    s_add_u32 s29, s22, 1404928
    buffer_load_dwordx4 v86, s[4:7], s29 offen lds
    s_waitcnt lgkmcnt(12)
    v_mfma_f32_32x32x16_bf16 a[80:95], v[36:39], v[176:179], a[80:95]
    ds_read_b64_tr_b16 v[64:65], v84 offset:36864
    ds_read_b64_tr_b16 v[66:67], v84 offset:37888
    s_waitcnt lgkmcnt(12)
    v_mfma_f32_32x32x16_bf16 a[96:111], v[40:43], v[176:179], a[96:111]
    ds_read_b64_tr_b16 v[68:69], v85 offset:36864
    ds_read_b64_tr_b16 v[70:71], v85 offset:37888
    s_add_u32 s28, s23, 51200
    s_mov_b32 m0, s28
    s_add_u32 s29, s22, 1404928
    buffer_load_dwordx4 v87, s[32:35], s29 offen lds
    s_waitcnt lgkmcnt(12)
    v_mfma_f32_32x32x16_bf16 a[0:15], v[44:47], v[180:183], a[0:15]
    ds_read_b64_tr_b16 v[16:17], v79 offset:40960
    ds_read_b64_tr_b16 v[18:19], v79 offset:41984
    s_add_u32 s29, s27, 24576
    buffer_load_dwordx4 v[232:235], v3, s[8:11], s29 offen offset:2048
    s_waitcnt lgkmcnt(12)
    v_mfma_f32_32x32x16_bf16 a[16:31], v[48:51], v[180:183], a[16:31]
    ds_read_b64_tr_b16 v[20:21], v80 offset:40960
    ds_read_b64_tr_b16 v[22:23], v80 offset:41984
    s_waitcnt lgkmcnt(12)
    v_mfma_f32_32x32x16_bf16 a[32:47], v[52:55], v[180:183], a[32:47]
    ds_read_b64_tr_b16 v[24:25], v81 offset:40960
    ds_read_b64_tr_b16 v[26:27], v81 offset:41984
    s_add_u32 s28, s23, 35840
    s_mov_b32 m0, s28
    s_add_u32 s29, s22, 1419264
    buffer_load_dwordx4 v86, s[4:7], s29 offen lds
    s_waitcnt lgkmcnt(12)
    v_mfma_f32_32x32x16_bf16 a[48:63], v[56:59], v[180:183], a[48:63]
    ds_read_b64_tr_b16 v[28:29], v82 offset:40960
    ds_read_b64_tr_b16 v[30:31], v82 offset:41984
    s_waitcnt lgkmcnt(12)
    v_mfma_f32_32x32x16_bf16 a[64:79], v[60:63], v[180:183], a[64:79]
    ds_read_b64_tr_b16 v[32:33], v83 offset:40960
    ds_read_b64_tr_b16 v[34:35], v83 offset:41984
    s_add_u32 s28, s23, 52224
    s_mov_b32 m0, s28
    s_add_u32 s29, s22, 1419264
    buffer_load_dwordx4 v87, s[32:35], s29 offen lds
    s_waitcnt lgkmcnt(12)
    v_mfma_f32_32x32x16_bf16 a[80:95], v[64:67], v[180:183], a[80:95]
    ds_read_b64_tr_b16 v[36:37], v84 offset:40960
    ds_read_b64_tr_b16 v[38:39], v84 offset:41984
    s_waitcnt lgkmcnt(12)
    v_mfma_f32_32x32x16_bf16 a[96:111], v[68:71], v[180:183], a[96:111]
    ds_read_b64_tr_b16 v[40:41], v85 offset:40960
    ds_read_b64_tr_b16 v[42:43], v85 offset:41984
    s_add_u32 s29, s27, 24576
    buffer_load_dwordx4 v[236:239], v3, s[8:11], s29 offen offset:3072
    s_waitcnt lgkmcnt(12)
    v_mfma_f32_32x32x16_bf16 a[0:15], v[16:19], v[184:187], a[0:15]
    ds_read_b64_tr_b16 v[44:45], v79 offset:45056
    ds_read_b64_tr_b16 v[46:47], v79 offset:46080
    s_waitcnt lgkmcnt(12)
    v_mfma_f32_32x32x16_bf16 a[16:31], v[20:23], v[184:187], a[16:31]
    ds_read_b64_tr_b16 v[48:49], v80 offset:45056
    ds_read_b64_tr_b16 v[50:51], v80 offset:46080
    s_waitcnt lgkmcnt(12)
    v_mfma_f32_32x32x16_bf16 a[32:47], v[24:27], v[184:187], a[32:47]
    ds_read_b64_tr_b16 v[52:53], v81 offset:45056
    ds_read_b64_tr_b16 v[54:55], v81 offset:46080
    s_waitcnt lgkmcnt(12)
    v_mfma_f32_32x32x16_bf16 a[48:63], v[28:31], v[184:187], a[48:63]
    ds_read_b64_tr_b16 v[56:57], v82 offset:45056
    ds_read_b64_tr_b16 v[58:59], v82 offset:46080
    s_waitcnt lgkmcnt(12)
    v_mfma_f32_32x32x16_bf16 a[64:79], v[32:35], v[184:187], a[64:79]
    ds_read_b64_tr_b16 v[60:61], v83 offset:45056
    ds_read_b64_tr_b16 v[62:63], v83 offset:46080
    s_waitcnt lgkmcnt(12)
    v_mfma_f32_32x32x16_bf16 a[80:95], v[36:39], v[184:187], a[80:95]
    ds_read_b64_tr_b16 v[64:65], v84 offset:45056
    ds_read_b64_tr_b16 v[66:67], v84 offset:46080
    s_waitcnt lgkmcnt(12)
    v_mfma_f32_32x32x16_bf16 a[96:111], v[40:43], v[184:187], a[96:111]
    ds_read_b64_tr_b16 v[68:69], v85 offset:45056
    ds_read_b64_tr_b16 v[70:71], v85 offset:46080
    s_waitcnt vmcnt(24)
    s_barrier
    s_waitcnt lgkmcnt(12)
    v_mfma_f32_32x32x16_bf16 a[0:15], v[44:47], v[188:191], a[0:15]
    ds_read_b64_tr_b16 v[16:17], v88 offset:0
    ds_read_b64_tr_b16 v[18:19], v88 offset:1024
    s_add_u32 s28, s23, 65536
    s_mov_b32 m0, s28
    s_add_u32 s29, s22, 1605632
    buffer_load_dwordx4 v86, s[4:7], s29 offen lds
    s_waitcnt lgkmcnt(12)
    v_mfma_f32_32x32x16_bf16 a[16:31], v[48:51], v[188:191], a[16:31]
    ds_read_b64_tr_b16 v[20:21], v89 offset:0
    ds_read_b64_tr_b16 v[22:23], v89 offset:1024
    s_waitcnt lgkmcnt(12)
    v_mfma_f32_32x32x16_bf16 a[32:47], v[52:55], v[188:191], a[32:47]
    ds_read_b64_tr_b16 v[24:25], v90 offset:0
    ds_read_b64_tr_b16 v[26:27], v90 offset:1024
    s_add_u32 s28, s23, 81920
    s_mov_b32 m0, s28
    s_add_u32 s29, s22, 1605632
    buffer_load_dwordx4 v87, s[32:35], s29 offen lds
    s_waitcnt lgkmcnt(12)
    v_mfma_f32_32x32x16_bf16 a[48:63], v[56:59], v[188:191], a[48:63]
    ds_read_b64_tr_b16 v[28:29], v91 offset:0
    ds_read_b64_tr_b16 v[30:31], v91 offset:1024
    s_waitcnt lgkmcnt(12)
    v_mfma_f32_32x32x16_bf16 a[64:79], v[60:63], v[188:191], a[64:79]
    ds_read_b64_tr_b16 v[32:33], v92 offset:0
    ds_read_b64_tr_b16 v[34:35], v92 offset:1024
    s_add_u32 s29, s27, 28672
    buffer_load_dwordx4 v[240:243], v3, s[8:11], s29 offen offset:0
    s_waitcnt lgkmcnt(12)
    v_mfma_f32_32x32x16_bf16 a[80:95], v[64:67], v[188:191], a[80:95]
    ds_read_b64_tr_b16 v[36:37], v93 offset:0
    ds_read_b64_tr_b16 v[38:39], v93 offset:1024
    s_waitcnt lgkmcnt(12)
    v_mfma_f32_32x32x16_bf16 a[96:111], v[68:71], v[188:191], a[96:111]
    ds_read_b64_tr_b16 v[40:41], v94 offset:0
    ds_read_b64_tr_b16 v[42:43], v94 offset:1024
    s_add_u32 s28, s23, 66560
    s_mov_b32 m0, s28
    s_add_u32 s29, s22, 1619968
    buffer_load_dwordx4 v86, s[4:7], s29 offen lds
    s_waitcnt lgkmcnt(12)
    v_mfma_f32_32x32x16_bf16 a[0:15], v[16:19], v[192:195], a[0:15]
    ds_read_b64_tr_b16 v[44:45], v88 offset:4096
    ds_read_b64_tr_b16 v[46:47], v88 offset:5120
    s_add_u32 s28, s23, 82944
    s_mov_b32 m0, s28
    s_add_u32 s29, s22, 1619968
    buffer_load_dwordx4 v87, s[32:35], s29 offen lds
    s_waitcnt lgkmcnt(12)
    v_mfma_f32_32x32x16_bf16 a[16:31], v[20:23], v[192:195], a[16:31]
    ds_read_b64_tr_b16 v[48:49], v89 offset:4096
    ds_read_b64_tr_b16 v[50:51], v89 offset:5120
    s_waitcnt lgkmcnt(12)
    v_mfma_f32_32x32x16_bf16 a[32:47], v[24:27], v[192:195], a[32:47]
    ds_read_b64_tr_b16 v[52:53], v90 offset:4096
    ds_read_b64_tr_b16 v[54:55], v90 offset:5120
    s_add_u32 s29, s27, 28672
    buffer_load_dwordx4 v[244:247], v3, s[8:11], s29 offen offset:1024
    s_waitcnt lgkmcnt(12)
    v_mfma_f32_32x32x16_bf16 a[48:63], v[28:31], v[192:195], a[48:63]
    ds_read_b64_tr_b16 v[56:57], v91 offset:4096
    ds_read_b64_tr_b16 v[58:59], v91 offset:5120
    s_waitcnt lgkmcnt(12)
    v_mfma_f32_32x32x16_bf16 a[64:79], v[32:35], v[192:195], a[64:79]
    ds_read_b64_tr_b16 v[60:61], v92 offset:4096
    ds_read_b64_tr_b16 v[62:63], v92 offset:5120
    s_add_u32 s28, s23, 67584
    s_mov_b32 m0, s28
    s_add_u32 s29, s22, 1634304
    buffer_load_dwordx4 v86, s[4:7], s29 offen lds
    s_waitcnt lgkmcnt(12)
    v_mfma_f32_32x32x16_bf16 a[80:95], v[36:39], v[192:195], a[80:95]
    ds_read_b64_tr_b16 v[64:65], v93 offset:4096
    ds_read_b64_tr_b16 v[66:67], v93 offset:5120
    s_waitcnt lgkmcnt(12)
    v_mfma_f32_32x32x16_bf16 a[96:111], v[40:43], v[192:195], a[96:111]
    ds_read_b64_tr_b16 v[68:69], v94 offset:4096
    ds_read_b64_tr_b16 v[70:71], v94 offset:5120
    s_add_u32 s28, s23, 83968
    s_mov_b32 m0, s28
    s_add_u32 s29, s22, 1634304
    buffer_load_dwordx4 v87, s[32:35], s29 offen lds
    s_waitcnt lgkmcnt(12)
    v_mfma_f32_32x32x16_bf16 a[0:15], v[44:47], v[196:199], a[0:15]
    ds_read_b64_tr_b16 v[16:17], v88 offset:8192
    ds_read_b64_tr_b16 v[18:19], v88 offset:9216
    s_add_u32 s29, s27, 28672
    buffer_load_dwordx4 v[248:251], v3, s[8:11], s29 offen offset:2048
    s_waitcnt lgkmcnt(12)
    v_mfma_f32_32x32x16_bf16 a[16:31], v[48:51], v[196:199], a[16:31]
    ds_read_b64_tr_b16 v[20:21], v89 offset:8192
    ds_read_b64_tr_b16 v[22:23], v89 offset:9216
    s_waitcnt lgkmcnt(12)
    v_mfma_f32_32x32x16_bf16 a[32:47], v[52:55], v[196:199], a[32:47]
    ds_read_b64_tr_b16 v[24:25], v90 offset:8192
    ds_read_b64_tr_b16 v[26:27], v90 offset:9216
    s_add_u32 s28, s23, 68608
    s_mov_b32 m0, s28
    s_add_u32 s29, s22, 1648640
    buffer_load_dwordx4 v86, s[4:7], s29 offen lds
    s_waitcnt lgkmcnt(12)
    v_mfma_f32_32x32x16_bf16 a[48:63], v[56:59], v[196:199], a[48:63]
    ds_read_b64_tr_b16 v[28:29], v91 offset:8192
    ds_read_b64_tr_b16 v[30:31], v91 offset:9216
    s_waitcnt lgkmcnt(12)
    v_mfma_f32_32x32x16_bf16 a[64:79], v[60:63], v[196:199], a[64:79]
    ds_read_b64_tr_b16 v[32:33], v92 offset:8192
    ds_read_b64_tr_b16 v[34:35], v92 offset:9216
    s_add_u32 s28, s23, 84992
    s_mov_b32 m0, s28
    s_add_u32 s29, s22, 1648640
    buffer_load_dwordx4 v87, s[32:35], s29 offen lds
    s_waitcnt lgkmcnt(12)
    v_mfma_f32_32x32x16_bf16 a[80:95], v[64:67], v[196:199], a[80:95]
    ds_read_b64_tr_b16 v[36:37], v93 offset:8192
    ds_read_b64_tr_b16 v[38:39], v93 offset:9216
    s_waitcnt lgkmcnt(12)
    v_mfma_f32_32x32x16_bf16 a[96:111], v[68:71], v[196:199], a[96:111]
    ds_read_b64_tr_b16 v[40:41], v94 offset:8192
    ds_read_b64_tr_b16 v[42:43], v94 offset:9216
    s_add_u32 s29, s27, 28672
    buffer_load_dwordx4 v[252:255], v3, s[8:11], s29 offen offset:3072
    s_waitcnt lgkmcnt(12)
    v_mfma_f32_32x32x16_bf16 a[0:15], v[16:19], v[200:203], a[0:15]
    ds_read_b64_tr_b16 v[44:45], v88 offset:12288
    ds_read_b64_tr_b16 v[46:47], v88 offset:13312
    s_waitcnt lgkmcnt(12)
    v_mfma_f32_32x32x16_bf16 a[16:31], v[20:23], v[200:203], a[16:31]
    ds_read_b64_tr_b16 v[48:49], v89 offset:12288
    ds_read_b64_tr_b16 v[50:51], v89 offset:13312
    s_waitcnt lgkmcnt(12)
    v_mfma_f32_32x32x16_bf16 a[32:47], v[24:27], v[200:203], a[32:47]
    ds_read_b64_tr_b16 v[52:53], v90 offset:12288
    ds_read_b64_tr_b16 v[54:55], v90 offset:13312
    s_waitcnt lgkmcnt(12)
    v_mfma_f32_32x32x16_bf16 a[48:63], v[28:31], v[200:203], a[48:63]
    ds_read_b64_tr_b16 v[56:57], v91 offset:12288
    ds_read_b64_tr_b16 v[58:59], v91 offset:13312
    s_waitcnt lgkmcnt(12)
    v_mfma_f32_32x32x16_bf16 a[64:79], v[32:35], v[200:203], a[64:79]
    ds_read_b64_tr_b16 v[60:61], v92 offset:12288
    ds_read_b64_tr_b16 v[62:63], v92 offset:13312
    s_waitcnt lgkmcnt(12)
    v_mfma_f32_32x32x16_bf16 a[80:95], v[36:39], v[200:203], a[80:95]
    ds_read_b64_tr_b16 v[64:65], v93 offset:12288
    ds_read_b64_tr_b16 v[66:67], v93 offset:13312
    s_waitcnt lgkmcnt(12)
    v_mfma_f32_32x32x16_bf16 a[96:111], v[40:43], v[200:203], a[96:111]
    ds_read_b64_tr_b16 v[68:69], v94 offset:12288
    ds_read_b64_tr_b16 v[70:71], v94 offset:13312
    s_waitcnt vmcnt(24)
    s_barrier
    s_waitcnt lgkmcnt(12)
    v_mfma_f32_32x32x16_bf16 a[0:15], v[44:47], v[204:207], a[0:15]
    ds_read_b64_tr_b16 v[16:17], v72 offset:0
    ds_read_b64_tr_b16 v[18:19], v72 offset:1024
    s_waitcnt lgkmcnt(12)
    v_mfma_f32_32x32x16_bf16 a[16:31], v[48:51], v[204:207], a[16:31]
    ds_read_b64_tr_b16 v[20:21], v73 offset:0
    ds_read_b64_tr_b16 v[22:23], v73 offset:1024
    s_waitcnt lgkmcnt(12)
    v_mfma_f32_32x32x16_bf16 a[32:47], v[52:55], v[204:207], a[32:47]
    ds_read_b64_tr_b16 v[24:25], v74 offset:0
    ds_read_b64_tr_b16 v[26:27], v74 offset:1024
    s_waitcnt lgkmcnt(12)
    v_mfma_f32_32x32x16_bf16 a[48:63], v[56:59], v[204:207], a[48:63]
    ds_read_b64_tr_b16 v[28:29], v75 offset:0
    ds_read_b64_tr_b16 v[30:31], v75 offset:1024
    s_waitcnt lgkmcnt(12)
    v_mfma_f32_32x32x16_bf16 a[64:79], v[60:63], v[204:207], a[64:79]
    ds_read_b64_tr_b16 v[32:33], v76 offset:0
    ds_read_b64_tr_b16 v[34:35], v76 offset:1024
    s_waitcnt lgkmcnt(12)
    v_mfma_f32_32x32x16_bf16 a[80:95], v[64:67], v[204:207], a[80:95]
    ds_read_b64_tr_b16 v[36:37], v77 offset:0
    ds_read_b64_tr_b16 v[38:39], v77 offset:1024
    s_waitcnt lgkmcnt(12)
    v_mfma_f32_32x32x16_bf16 a[96:111], v[68:71], v[204:207], a[96:111]
    ds_read_b64_tr_b16 v[40:41], v78 offset:0
    ds_read_b64_tr_b16 v[42:43], v78 offset:1024
    s_waitcnt lgkmcnt(12)
    v_mfma_f32_32x32x16_bf16 a[0:15], v[16:19], v[208:211], a[0:15]
    ds_read_b64_tr_b16 v[44:45], v72 offset:4096
    ds_read_b64_tr_b16 v[46:47], v72 offset:5120
    s_waitcnt lgkmcnt(12)
    v_mfma_f32_32x32x16_bf16 a[16:31], v[20:23], v[208:211], a[16:31]
    ds_read_b64_tr_b16 v[48:49], v73 offset:4096
    ds_read_b64_tr_b16 v[50:51], v73 offset:5120
    s_waitcnt lgkmcnt(12)
    v_mfma_f32_32x32x16_bf16 a[32:47], v[24:27], v[208:211], a[32:47]
    ds_read_b64_tr_b16 v[52:53], v74 offset:4096
    ds_read_b64_tr_b16 v[54:55], v74 offset:5120
    s_waitcnt lgkmcnt(12)
    v_mfma_f32_32x32x16_bf16 a[48:63], v[28:31], v[208:211], a[48:63]
    ds_read_b64_tr_b16 v[56:57], v75 offset:4096
    ds_read_b64_tr_b16 v[58:59], v75 offset:5120
    s_waitcnt lgkmcnt(12)
    v_mfma_f32_32x32x16_bf16 a[64:79], v[32:35], v[208:211], a[64:79]
    ds_read_b64_tr_b16 v[60:61], v76 offset:4096
    ds_read_b64_tr_b16 v[62:63], v76 offset:5120
    s_waitcnt lgkmcnt(12)
    v_mfma_f32_32x32x16_bf16 a[80:95], v[36:39], v[208:211], a[80:95]
    ds_read_b64_tr_b16 v[64:65], v77 offset:4096
    ds_read_b64_tr_b16 v[66:67], v77 offset:5120
    s_waitcnt lgkmcnt(12)
    v_mfma_f32_32x32x16_bf16 a[96:111], v[40:43], v[208:211], a[96:111]
    ds_read_b64_tr_b16 v[68:69], v78 offset:4096
    ds_read_b64_tr_b16 v[70:71], v78 offset:5120
    s_waitcnt lgkmcnt(12)
    v_mfma_f32_32x32x16_bf16 a[0:15], v[44:47], v[212:215], a[0:15]
    ds_read_b64_tr_b16 v[16:17], v72 offset:8192
    ds_read_b64_tr_b16 v[18:19], v72 offset:9216
    s_waitcnt lgkmcnt(12)
    v_mfma_f32_32x32x16_bf16 a[16:31], v[48:51], v[212:215], a[16:31]
    ds_read_b64_tr_b16 v[20:21], v73 offset:8192
    ds_read_b64_tr_b16 v[22:23], v73 offset:9216
    s_waitcnt lgkmcnt(12)
    v_mfma_f32_32x32x16_bf16 a[32:47], v[52:55], v[212:215], a[32:47]
    ds_read_b64_tr_b16 v[24:25], v74 offset:8192
    ds_read_b64_tr_b16 v[26:27], v74 offset:9216
    s_waitcnt lgkmcnt(12)
    v_mfma_f32_32x32x16_bf16 a[48:63], v[56:59], v[212:215], a[48:63]
    ds_read_b64_tr_b16 v[28:29], v75 offset:8192
    ds_read_b64_tr_b16 v[30:31], v75 offset:9216
    s_waitcnt lgkmcnt(12)
    v_mfma_f32_32x32x16_bf16 a[64:79], v[60:63], v[212:215], a[64:79]
    ds_read_b64_tr_b16 v[32:33], v76 offset:8192
    ds_read_b64_tr_b16 v[34:35], v76 offset:9216
    s_waitcnt lgkmcnt(12)
    v_mfma_f32_32x32x16_bf16 a[80:95], v[64:67], v[212:215], a[80:95]
    ds_read_b64_tr_b16 v[36:37], v77 offset:8192
    ds_read_b64_tr_b16 v[38:39], v77 offset:9216
    s_waitcnt lgkmcnt(12)
    v_mfma_f32_32x32x16_bf16 a[96:111], v[68:71], v[212:215], a[96:111]
    ds_read_b64_tr_b16 v[40:41], v78 offset:8192
    ds_read_b64_tr_b16 v[42:43], v78 offset:9216
    s_waitcnt lgkmcnt(12)
    v_mfma_f32_32x32x16_bf16 a[0:15], v[16:19], v[216:219], a[0:15]
    ds_read_b64_tr_b16 v[44:45], v72 offset:12288
    ds_read_b64_tr_b16 v[46:47], v72 offset:13312
    s_waitcnt lgkmcnt(12)
    v_mfma_f32_32x32x16_bf16 a[16:31], v[20:23], v[216:219], a[16:31]
    ds_read_b64_tr_b16 v[48:49], v73 offset:12288
    ds_read_b64_tr_b16 v[50:51], v73 offset:13312
    s_waitcnt lgkmcnt(12)
    v_mfma_f32_32x32x16_bf16 a[32:47], v[24:27], v[216:219], a[32:47]
    ds_read_b64_tr_b16 v[52:53], v74 offset:12288
    ds_read_b64_tr_b16 v[54:55], v74 offset:13312
    s_waitcnt lgkmcnt(12)
    v_mfma_f32_32x32x16_bf16 a[48:63], v[28:31], v[216:219], a[48:63]
    ds_read_b64_tr_b16 v[56:57], v75 offset:12288
    ds_read_b64_tr_b16 v[58:59], v75 offset:13312
    s_waitcnt lgkmcnt(12)
    v_mfma_f32_32x32x16_bf16 a[64:79], v[32:35], v[216:219], a[64:79]
    ds_read_b64_tr_b16 v[60:61], v76 offset:12288
    ds_read_b64_tr_b16 v[62:63], v76 offset:13312
    s_waitcnt lgkmcnt(12)
    v_mfma_f32_32x32x16_bf16 a[80:95], v[36:39], v[216:219], a[80:95]
    ds_read_b64_tr_b16 v[64:65], v77 offset:12288
    ds_read_b64_tr_b16 v[66:67], v77 offset:13312
    s_waitcnt lgkmcnt(12)
    v_mfma_f32_32x32x16_bf16 a[96:111], v[40:43], v[216:219], a[96:111]
    ds_read_b64_tr_b16 v[68:69], v78 offset:12288
    ds_read_b64_tr_b16 v[70:71], v78 offset:13312
    s_waitcnt vmcnt(12)
    s_barrier
    s_waitcnt lgkmcnt(12)
    v_mfma_f32_32x32x16_bf16 a[0:15], v[44:47], v[220:223], a[0:15]
    ds_read_b64_tr_b16 v[16:17], v72 offset:32768
    ds_read_b64_tr_b16 v[18:19], v72 offset:33792
    s_waitcnt lgkmcnt(12)
    v_mfma_f32_32x32x16_bf16 a[16:31], v[48:51], v[220:223], a[16:31]
    ds_read_b64_tr_b16 v[20:21], v73 offset:32768
    ds_read_b64_tr_b16 v[22:23], v73 offset:33792
    s_waitcnt lgkmcnt(12)
    v_mfma_f32_32x32x16_bf16 a[32:47], v[52:55], v[220:223], a[32:47]
    ds_read_b64_tr_b16 v[24:25], v74 offset:32768
    ds_read_b64_tr_b16 v[26:27], v74 offset:33792
    s_waitcnt lgkmcnt(12)
    v_mfma_f32_32x32x16_bf16 a[48:63], v[56:59], v[220:223], a[48:63]
    ds_read_b64_tr_b16 v[28:29], v75 offset:32768
    ds_read_b64_tr_b16 v[30:31], v75 offset:33792
    s_waitcnt lgkmcnt(12)
    v_mfma_f32_32x32x16_bf16 a[64:79], v[60:63], v[220:223], a[64:79]
    ds_read_b64_tr_b16 v[32:33], v76 offset:32768
    ds_read_b64_tr_b16 v[34:35], v76 offset:33792
    s_waitcnt lgkmcnt(12)
    v_mfma_f32_32x32x16_bf16 a[80:95], v[64:67], v[220:223], a[80:95]
    ds_read_b64_tr_b16 v[36:37], v77 offset:32768
    ds_read_b64_tr_b16 v[38:39], v77 offset:33792
    s_waitcnt lgkmcnt(12)
    v_mfma_f32_32x32x16_bf16 a[96:111], v[68:71], v[220:223], a[96:111]
    ds_read_b64_tr_b16 v[40:41], v78 offset:32768
    ds_read_b64_tr_b16 v[42:43], v78 offset:33792
    s_waitcnt lgkmcnt(12)
    v_mfma_f32_32x32x16_bf16 a[0:15], v[16:19], v[224:227], a[0:15]
    ds_read_b64_tr_b16 v[44:45], v72 offset:36864
    ds_read_b64_tr_b16 v[46:47], v72 offset:37888
    s_waitcnt lgkmcnt(12)
    v_mfma_f32_32x32x16_bf16 a[16:31], v[20:23], v[224:227], a[16:31]
    ds_read_b64_tr_b16 v[48:49], v73 offset:36864
    ds_read_b64_tr_b16 v[50:51], v73 offset:37888
    s_waitcnt lgkmcnt(12)
    v_mfma_f32_32x32x16_bf16 a[32:47], v[24:27], v[224:227], a[32:47]
    ds_read_b64_tr_b16 v[52:53], v74 offset:36864
    ds_read_b64_tr_b16 v[54:55], v74 offset:37888
    s_waitcnt lgkmcnt(12)
    v_mfma_f32_32x32x16_bf16 a[48:63], v[28:31], v[224:227], a[48:63]
    ds_read_b64_tr_b16 v[56:57], v75 offset:36864
    ds_read_b64_tr_b16 v[58:59], v75 offset:37888
    s_waitcnt lgkmcnt(12)
    v_mfma_f32_32x32x16_bf16 a[64:79], v[32:35], v[224:227], a[64:79]
    ds_read_b64_tr_b16 v[60:61], v76 offset:36864
    ds_read_b64_tr_b16 v[62:63], v76 offset:37888
    s_waitcnt lgkmcnt(12)
    v_mfma_f32_32x32x16_bf16 a[80:95], v[36:39], v[224:227], a[80:95]
    ds_read_b64_tr_b16 v[64:65], v77 offset:36864
    ds_read_b64_tr_b16 v[66:67], v77 offset:37888
    s_waitcnt lgkmcnt(12)
    v_mfma_f32_32x32x16_bf16 a[96:111], v[40:43], v[224:227], a[96:111]
    ds_read_b64_tr_b16 v[68:69], v78 offset:36864
    ds_read_b64_tr_b16 v[70:71], v78 offset:37888
    s_waitcnt lgkmcnt(12)
    v_mfma_f32_32x32x16_bf16 a[0:15], v[44:47], v[228:231], a[0:15]
    ds_read_b64_tr_b16 v[16:17], v72 offset:40960
    ds_read_b64_tr_b16 v[18:19], v72 offset:41984
    s_waitcnt lgkmcnt(12)
    v_mfma_f32_32x32x16_bf16 a[16:31], v[48:51], v[228:231], a[16:31]
    ds_read_b64_tr_b16 v[20:21], v73 offset:40960
    ds_read_b64_tr_b16 v[22:23], v73 offset:41984
    s_waitcnt lgkmcnt(12)
    v_mfma_f32_32x32x16_bf16 a[32:47], v[52:55], v[228:231], a[32:47]
    ds_read_b64_tr_b16 v[24:25], v74 offset:40960
    ds_read_b64_tr_b16 v[26:27], v74 offset:41984
    s_waitcnt lgkmcnt(12)
    v_mfma_f32_32x32x16_bf16 a[48:63], v[56:59], v[228:231], a[48:63]
    ds_read_b64_tr_b16 v[28:29], v75 offset:40960
    ds_read_b64_tr_b16 v[30:31], v75 offset:41984
    s_waitcnt lgkmcnt(12)
    v_mfma_f32_32x32x16_bf16 a[64:79], v[60:63], v[228:231], a[64:79]
    ds_read_b64_tr_b16 v[32:33], v76 offset:40960
    ds_read_b64_tr_b16 v[34:35], v76 offset:41984
    s_waitcnt lgkmcnt(12)
    v_mfma_f32_32x32x16_bf16 a[80:95], v[64:67], v[228:231], a[80:95]
    ds_read_b64_tr_b16 v[36:37], v77 offset:40960
    ds_read_b64_tr_b16 v[38:39], v77 offset:41984
    s_waitcnt lgkmcnt(12)
    v_mfma_f32_32x32x16_bf16 a[96:111], v[68:71], v[228:231], a[96:111]
    ds_read_b64_tr_b16 v[40:41], v78 offset:40960
    ds_read_b64_tr_b16 v[42:43], v78 offset:41984
    s_waitcnt lgkmcnt(12)
    v_mfma_f32_32x32x16_bf16 a[0:15], v[16:19], v[232:235], a[0:15]
    ds_read_b64_tr_b16 v[44:45], v72 offset:45056
    ds_read_b64_tr_b16 v[46:47], v72 offset:46080
    s_waitcnt lgkmcnt(12)
    v_mfma_f32_32x32x16_bf16 a[16:31], v[20:23], v[232:235], a[16:31]
    ds_read_b64_tr_b16 v[48:49], v73 offset:45056
    ds_read_b64_tr_b16 v[50:51], v73 offset:46080
    s_waitcnt lgkmcnt(12)
    v_mfma_f32_32x32x16_bf16 a[32:47], v[24:27], v[232:235], a[32:47]
    ds_read_b64_tr_b16 v[52:53], v74 offset:45056
    ds_read_b64_tr_b16 v[54:55], v74 offset:46080
    s_waitcnt lgkmcnt(12)
    v_mfma_f32_32x32x16_bf16 a[48:63], v[28:31], v[232:235], a[48:63]
    ds_read_b64_tr_b16 v[56:57], v75 offset:45056
    ds_read_b64_tr_b16 v[58:59], v75 offset:46080
    s_waitcnt lgkmcnt(12)
    v_mfma_f32_32x32x16_bf16 a[64:79], v[32:35], v[232:235], a[64:79]
    ds_read_b64_tr_b16 v[60:61], v76 offset:45056
    ds_read_b64_tr_b16 v[62:63], v76 offset:46080
    s_waitcnt lgkmcnt(12)
    v_mfma_f32_32x32x16_bf16 a[80:95], v[36:39], v[232:235], a[80:95]
    ds_read_b64_tr_b16 v[64:65], v77 offset:45056
    ds_read_b64_tr_b16 v[66:67], v77 offset:46080
    s_waitcnt lgkmcnt(12)
    v_mfma_f32_32x32x16_bf16 a[96:111], v[40:43], v[232:235], a[96:111]
    ds_read_b64_tr_b16 v[68:69], v78 offset:45056
    ds_read_b64_tr_b16 v[70:71], v78 offset:46080
    s_waitcnt vmcnt(0)
    s_barrier
    s_waitcnt lgkmcnt(12)
    v_mfma_f32_32x32x16_bf16 a[0:15], v[44:47], v[236:239], a[0:15]
    ds_read_b64_tr_b16 v[44:45], v79 offset:0
    ds_read_b64_tr_b16 v[46:47], v79 offset:1024
    s_waitcnt lgkmcnt(12)
    v_mfma_f32_32x32x16_bf16 a[16:31], v[48:51], v[236:239], a[16:31]
    ds_read_b64_tr_b16 v[48:49], v79 offset:4096
    ds_read_b64_tr_b16 v[50:51], v79 offset:5120
    s_waitcnt lgkmcnt(12)
    v_mfma_f32_32x32x16_bf16 a[32:47], v[52:55], v[236:239], a[32:47]
    ds_read_b64_tr_b16 v[52:53], v79 offset:8192
    ds_read_b64_tr_b16 v[54:55], v79 offset:9216
    s_waitcnt lgkmcnt(12)
    v_mfma_f32_32x32x16_bf16 a[48:63], v[56:59], v[236:239], a[48:63]
    ds_read_b64_tr_b16 v[56:57], v79 offset:12288
    ds_read_b64_tr_b16 v[58:59], v79 offset:13312
    s_waitcnt lgkmcnt(12)
    v_mfma_f32_32x32x16_bf16 a[64:79], v[60:63], v[236:239], a[64:79]
    s_waitcnt lgkmcnt(10)
    v_mfma_f32_32x32x16_bf16 a[80:95], v[64:67], v[236:239], a[80:95]
    s_waitcnt lgkmcnt(8)
    v_mfma_f32_32x32x16_bf16 a[96:111], v[68:71], v[236:239], a[96:111]
    s_mul_i32 s27, s26, 114688
    s_mul_i32 s28, s20, 7168
    s_add_u32 s27, s27, s28
    s_add_u32 s27, s27, 16777216
    s_add_u32 s28, s27, 4096
    s_waitcnt lgkmcnt(6)
    v_mfma_f32_32x32x16_bf16 a[0:15], v[44:47], v[240:243], a[0:15]
    ds_read_b64_tr_b16 v[16:17], v80 offset:0
    ds_read_b64_tr_b16 v[18:19], v80 offset:1024
    s_waitcnt lgkmcnt(6)
    v_mfma_f32_32x32x16_bf16 a[0:15], v[48:51], v[244:247], a[0:15]
    ds_read_b64_tr_b16 v[20:21], v80 offset:4096
    ds_read_b64_tr_b16 v[22:23], v80 offset:5120
    s_waitcnt lgkmcnt(6)
    v_mfma_f32_32x32x16_bf16 a[0:15], v[52:55], v[248:251], a[0:15]
    ds_read_b64_tr_b16 v[24:25], v80 offset:8192
    ds_read_b64_tr_b16 v[26:27], v80 offset:9216
    s_waitcnt lgkmcnt(6)
    v_mfma_f32_32x32x16_bf16 a[0:15], v[56:59], v[252:255], a[0:15]
    ds_read_b64_tr_b16 v[28:29], v80 offset:12288
    ds_read_b64_tr_b16 v[30:31], v80 offset:13312
    s_waitcnt lgkmcnt(6)
    v_mfma_f32_32x32x16_bf16 a[16:31], v[16:19], v[240:243], a[16:31]
    ds_read_b64_tr_b16 v[44:45], v81 offset:0
    ds_read_b64_tr_b16 v[46:47], v81 offset:1024
    s_waitcnt lgkmcnt(6)
    v_mfma_f32_32x32x16_bf16 a[16:31], v[20:23], v[244:247], a[16:31]
    ds_read_b64_tr_b16 v[48:49], v81 offset:4096
    ds_read_b64_tr_b16 v[50:51], v81 offset:5120
    v_accvgpr_read_b32 v96, a0
    v_accvgpr_read_b32 v97, a1
    v_accvgpr_read_b32 v98, a2
    v_accvgpr_read_b32 v99, a3
    v_accvgpr_read_b32 v100, a4
    v_accvgpr_read_b32 v101, a5
    v_accvgpr_read_b32 v102, a6
    v_accvgpr_read_b32 v103, a7
    v_accvgpr_read_b32 v104, a8
    v_accvgpr_read_b32 v105, a9
    v_accvgpr_read_b32 v106, a10
    v_accvgpr_read_b32 v107, a11
    v_accvgpr_read_b32 v108, a12
    v_accvgpr_read_b32 v109, a13
    s_waitcnt lgkmcnt(6)
    v_mfma_f32_32x32x16_bf16 a[16:31], v[24:27], v[248:251], a[16:31]
    ds_read_b64_tr_b16 v[52:53], v81 offset:8192
    ds_read_b64_tr_b16 v[54:55], v81 offset:9216
    v_accvgpr_read_b32 v110, a14
    v_accvgpr_read_b32 v111, a15
    v_max_f32 v96, 0, v96
    v_max_f32 v97, 0, v97
    v_max_f32 v98, 0, v98
    v_max_f32 v99, 0, v99
    v_max_f32 v100, 0, v100
    v_max_f32 v101, 0, v101
    v_max_f32 v102, 0, v102
    v_max_f32 v103, 0, v103
    v_mul_f32 v96, v96, v104
    v_mul_f32 v97, v97, v105
    v_mul_f32 v98, v98, v106
    v_mul_f32 v99, v99, v107
    s_waitcnt lgkmcnt(6)
    v_mfma_f32_32x32x16_bf16 a[16:31], v[28:31], v[252:255], a[16:31]
    ds_read_b64_tr_b16 v[56:57], v81 offset:12288
    ds_read_b64_tr_b16 v[58:59], v81 offset:13312
    v_mul_f32 v100, v100, v108
    v_mul_f32 v101, v101, v109
    v_mul_f32 v102, v102, v110
    v_mul_f32 v103, v103, v111
    v_cvt_pk_bf16_f32 v112, v96, v97
    v_cvt_pk_bf16_f32 v113, v98, v99
    v_cvt_pk_bf16_f32 v114, v100, v101
    v_cvt_pk_bf16_f32 v115, v102, v103
    s_nop 1
    v_permlane32_swap_b32 v112, v114
    v_permlane32_swap_b32 v113, v115
    buffer_store_dwordx4 v[112:115], v3, s[8:11], s27 offen offset:0 sc1
    s_waitcnt lgkmcnt(6)
    v_mfma_f32_32x32x16_bf16 a[32:47], v[44:47], v[240:243], a[32:47]
    ds_read_b64_tr_b16 v[16:17], v82 offset:0
    ds_read_b64_tr_b16 v[18:19], v82 offset:1024
    s_waitcnt lgkmcnt(6)
    v_mfma_f32_32x32x16_bf16 a[32:47], v[48:51], v[244:247], a[32:47]
    ds_read_b64_tr_b16 v[20:21], v82 offset:4096
    ds_read_b64_tr_b16 v[22:23], v82 offset:5120
    v_accvgpr_read_b32 v96, a16
    v_accvgpr_read_b32 v97, a17
    v_accvgpr_read_b32 v98, a18
    v_accvgpr_read_b32 v99, a19
    v_accvgpr_read_b32 v100, a20
    v_accvgpr_read_b32 v101, a21
    v_accvgpr_read_b32 v102, a22
    v_accvgpr_read_b32 v103, a23
    v_accvgpr_read_b32 v104, a24
    v_accvgpr_read_b32 v105, a25
    v_accvgpr_read_b32 v106, a26
    v_accvgpr_read_b32 v107, a27
    v_accvgpr_read_b32 v108, a28
    v_accvgpr_read_b32 v109, a29
    s_waitcnt lgkmcnt(6)
    v_mfma_f32_32x32x16_bf16 a[32:47], v[52:55], v[248:251], a[32:47]
    ds_read_b64_tr_b16 v[24:25], v82 offset:8192
    ds_read_b64_tr_b16 v[26:27], v82 offset:9216
    v_accvgpr_read_b32 v110, a30
    v_accvgpr_read_b32 v111, a31
    v_max_f32 v96, 0, v96
    v_max_f32 v97, 0, v97
    v_max_f32 v98, 0, v98
    v_max_f32 v99, 0, v99
    v_max_f32 v100, 0, v100
    v_max_f32 v101, 0, v101
    v_max_f32 v102, 0, v102
    v_max_f32 v103, 0, v103
    v_mul_f32 v96, v96, v104
    v_mul_f32 v97, v97, v105
    v_mul_f32 v98, v98, v106
    v_mul_f32 v99, v99, v107
    s_waitcnt lgkmcnt(6)
    v_mfma_f32_32x32x16_bf16 a[32:47], v[56:59], v[252:255], a[32:47]
    ds_read_b64_tr_b16 v[28:29], v82 offset:12288
    ds_read_b64_tr_b16 v[30:31], v82 offset:13312
    v_mul_f32 v100, v100, v108
    v_mul_f32 v101, v101, v109
    v_mul_f32 v102, v102, v110
    v_mul_f32 v103, v103, v111
    v_cvt_pk_bf16_f32 v112, v96, v97
    v_cvt_pk_bf16_f32 v113, v98, v99
    v_cvt_pk_bf16_f32 v114, v100, v101
    v_cvt_pk_bf16_f32 v115, v102, v103
    s_nop 1
    v_permlane32_swap_b32 v112, v114
    v_permlane32_swap_b32 v113, v115
    buffer_store_dwordx4 v[112:115], v3, s[8:11], s27 offen offset:1024 sc1
    s_waitcnt lgkmcnt(6)
    v_mfma_f32_32x32x16_bf16 a[48:63], v[16:19], v[240:243], a[48:63]
    ds_read_b64_tr_b16 v[44:45], v83 offset:0
    ds_read_b64_tr_b16 v[46:47], v83 offset:1024
    s_waitcnt lgkmcnt(6)
    v_mfma_f32_32x32x16_bf16 a[48:63], v[20:23], v[244:247], a[48:63]
    ds_read_b64_tr_b16 v[48:49], v83 offset:4096
    ds_read_b64_tr_b16 v[50:51], v83 offset:5120
    v_accvgpr_read_b32 v96, a32
    v_accvgpr_read_b32 v97, a33
    v_accvgpr_read_b32 v98, a34
    v_accvgpr_read_b32 v99, a35
    v_accvgpr_read_b32 v100, a36
    v_accvgpr_read_b32 v101, a37
    v_accvgpr_read_b32 v102, a38
    v_accvgpr_read_b32 v103, a39
    v_accvgpr_read_b32 v104, a40
    v_accvgpr_read_b32 v105, a41
    v_accvgpr_read_b32 v106, a42
    v_accvgpr_read_b32 v107, a43
    v_accvgpr_read_b32 v108, a44
    v_accvgpr_read_b32 v109, a45
    s_waitcnt lgkmcnt(6)
    v_mfma_f32_32x32x16_bf16 a[48:63], v[24:27], v[248:251], a[48:63]
    ds_read_b64_tr_b16 v[52:53], v83 offset:8192
    ds_read_b64_tr_b16 v[54:55], v83 offset:9216
    v_accvgpr_read_b32 v110, a46
    v_accvgpr_read_b32 v111, a47
    v_max_f32 v96, 0, v96
    v_max_f32 v97, 0, v97
    v_max_f32 v98, 0, v98
    v_max_f32 v99, 0, v99
    v_max_f32 v100, 0, v100
    v_max_f32 v101, 0, v101
    v_max_f32 v102, 0, v102
    v_max_f32 v103, 0, v103
    v_mul_f32 v96, v96, v104
    v_mul_f32 v97, v97, v105
    v_mul_f32 v98, v98, v106
    v_mul_f32 v99, v99, v107
    s_waitcnt lgkmcnt(6)
    v_mfma_f32_32x32x16_bf16 a[48:63], v[28:31], v[252:255], a[48:63]
    ds_read_b64_tr_b16 v[56:57], v83 offset:12288
    ds_read_b64_tr_b16 v[58:59], v83 offset:13312
    v_mul_f32 v100, v100, v108
    v_mul_f32 v101, v101, v109
    v_mul_f32 v102, v102, v110
    v_mul_f32 v103, v103, v111
    v_cvt_pk_bf16_f32 v112, v96, v97
    v_cvt_pk_bf16_f32 v113, v98, v99
    v_cvt_pk_bf16_f32 v114, v100, v101
    v_cvt_pk_bf16_f32 v115, v102, v103
    s_nop 1
    v_permlane32_swap_b32 v112, v114
    v_permlane32_swap_b32 v113, v115
    buffer_store_dwordx4 v[112:115], v3, s[8:11], s27 offen offset:2048 sc1
    s_waitcnt lgkmcnt(6)
    v_mfma_f32_32x32x16_bf16 a[64:79], v[44:47], v[240:243], a[64:79]
    ds_read_b64_tr_b16 v[16:17], v84 offset:0
    ds_read_b64_tr_b16 v[18:19], v84 offset:1024
    s_waitcnt lgkmcnt(6)
    v_mfma_f32_32x32x16_bf16 a[64:79], v[48:51], v[244:247], a[64:79]
    ds_read_b64_tr_b16 v[20:21], v84 offset:4096
    ds_read_b64_tr_b16 v[22:23], v84 offset:5120
    v_accvgpr_read_b32 v96, a48
    v_accvgpr_read_b32 v97, a49
    v_accvgpr_read_b32 v98, a50
    v_accvgpr_read_b32 v99, a51
    v_accvgpr_read_b32 v100, a52
    v_accvgpr_read_b32 v101, a53
    v_accvgpr_read_b32 v102, a54
    v_accvgpr_read_b32 v103, a55
    v_accvgpr_read_b32 v104, a56
    v_accvgpr_read_b32 v105, a57
    v_accvgpr_read_b32 v106, a58
    v_accvgpr_read_b32 v107, a59
    v_accvgpr_read_b32 v108, a60
    v_accvgpr_read_b32 v109, a61
    s_waitcnt lgkmcnt(6)
    v_mfma_f32_32x32x16_bf16 a[64:79], v[52:55], v[248:251], a[64:79]
    ds_read_b64_tr_b16 v[24:25], v84 offset:8192
    ds_read_b64_tr_b16 v[26:27], v84 offset:9216
    v_accvgpr_read_b32 v110, a62
    v_accvgpr_read_b32 v111, a63
    v_max_f32 v96, 0, v96
    v_max_f32 v97, 0, v97
    v_max_f32 v98, 0, v98
    v_max_f32 v99, 0, v99
    v_max_f32 v100, 0, v100
    v_max_f32 v101, 0, v101
    v_max_f32 v102, 0, v102
    v_max_f32 v103, 0, v103
    v_mul_f32 v96, v96, v104
    v_mul_f32 v97, v97, v105
    v_mul_f32 v98, v98, v106
    v_mul_f32 v99, v99, v107
    s_waitcnt lgkmcnt(6)
    v_mfma_f32_32x32x16_bf16 a[64:79], v[56:59], v[252:255], a[64:79]
    ds_read_b64_tr_b16 v[28:29], v84 offset:12288
    ds_read_b64_tr_b16 v[30:31], v84 offset:13312
    v_mul_f32 v100, v100, v108
    v_mul_f32 v101, v101, v109
    v_mul_f32 v102, v102, v110
    v_mul_f32 v103, v103, v111
    v_cvt_pk_bf16_f32 v112, v96, v97
    v_cvt_pk_bf16_f32 v113, v98, v99
    v_cvt_pk_bf16_f32 v114, v100, v101
    v_cvt_pk_bf16_f32 v115, v102, v103
    s_nop 1
    v_permlane32_swap_b32 v112, v114
    v_permlane32_swap_b32 v113, v115
    buffer_store_dwordx4 v[112:115], v3, s[8:11], s27 offen offset:3072 sc1
    s_waitcnt lgkmcnt(6)
    v_mfma_f32_32x32x16_bf16 a[80:95], v[16:19], v[240:243], a[80:95]
    ds_read_b64_tr_b16 v[44:45], v85 offset:0
    ds_read_b64_tr_b16 v[46:47], v85 offset:1024
    s_waitcnt lgkmcnt(6)
    v_mfma_f32_32x32x16_bf16 a[80:95], v[20:23], v[244:247], a[80:95]
    ds_read_b64_tr_b16 v[48:49], v85 offset:4096
    ds_read_b64_tr_b16 v[50:51], v85 offset:5120
    v_accvgpr_read_b32 v96, a64
    v_accvgpr_read_b32 v97, a65
    v_accvgpr_read_b32 v98, a66
    v_accvgpr_read_b32 v99, a67
    v_accvgpr_read_b32 v100, a68
    v_accvgpr_read_b32 v101, a69
    v_accvgpr_read_b32 v102, a70
    v_accvgpr_read_b32 v103, a71
    v_accvgpr_read_b32 v104, a72
    v_accvgpr_read_b32 v105, a73
    v_accvgpr_read_b32 v106, a74
    v_accvgpr_read_b32 v107, a75
    v_accvgpr_read_b32 v108, a76
    v_accvgpr_read_b32 v109, a77
    s_waitcnt lgkmcnt(6)
    v_mfma_f32_32x32x16_bf16 a[80:95], v[24:27], v[248:251], a[80:95]
    ds_read_b64_tr_b16 v[52:53], v85 offset:8192
    ds_read_b64_tr_b16 v[54:55], v85 offset:9216
    v_accvgpr_read_b32 v110, a78
    v_accvgpr_read_b32 v111, a79
    v_max_f32 v96, 0, v96
    v_max_f32 v97, 0, v97
    v_max_f32 v98, 0, v98
    v_max_f32 v99, 0, v99
    v_max_f32 v100, 0, v100
    v_max_f32 v101, 0, v101
    v_max_f32 v102, 0, v102
    v_max_f32 v103, 0, v103
    v_mul_f32 v96, v96, v104
    v_mul_f32 v97, v97, v105
    v_mul_f32 v98, v98, v106
    v_mul_f32 v99, v99, v107
    s_waitcnt lgkmcnt(6)
    v_mfma_f32_32x32x16_bf16 a[80:95], v[28:31], v[252:255], a[80:95]
    ds_read_b64_tr_b16 v[56:57], v85 offset:12288
    ds_read_b64_tr_b16 v[58:59], v85 offset:13312
    v_mul_f32 v100, v100, v108
    v_mul_f32 v101, v101, v109
    v_mul_f32 v102, v102, v110
    v_mul_f32 v103, v103, v111
    v_cvt_pk_bf16_f32 v112, v96, v97
    v_cvt_pk_bf16_f32 v113, v98, v99
    v_cvt_pk_bf16_f32 v114, v100, v101
    v_cvt_pk_bf16_f32 v115, v102, v103
    s_nop 1
    v_permlane32_swap_b32 v112, v114
    v_permlane32_swap_b32 v113, v115
    buffer_store_dwordx4 v[112:115], v3, s[8:11], s28 offen offset:0 sc1
    s_waitcnt lgkmcnt(6)
    v_mfma_f32_32x32x16_bf16 a[96:111], v[44:47], v[240:243], a[96:111]
    s_waitcnt lgkmcnt(4)
    v_mfma_f32_32x32x16_bf16 a[96:111], v[48:51], v[244:247], a[96:111]
    v_accvgpr_read_b32 v96, a80
    v_accvgpr_read_b32 v97, a81
    v_accvgpr_read_b32 v98, a82
    v_accvgpr_read_b32 v99, a83
    v_accvgpr_read_b32 v100, a84
    v_accvgpr_read_b32 v101, a85
    v_accvgpr_read_b32 v102, a86
    v_accvgpr_read_b32 v103, a87
    v_accvgpr_read_b32 v104, a88
    v_accvgpr_read_b32 v105, a89
    v_accvgpr_read_b32 v106, a90
    v_accvgpr_read_b32 v107, a91
    v_accvgpr_read_b32 v108, a92
    v_accvgpr_read_b32 v109, a93
    s_waitcnt lgkmcnt(2)
    v_mfma_f32_32x32x16_bf16 a[96:111], v[52:55], v[248:251], a[96:111]
    v_accvgpr_read_b32 v110, a94
    v_accvgpr_read_b32 v111, a95
    v_max_f32 v96, 0, v96
    v_max_f32 v97, 0, v97
    v_max_f32 v98, 0, v98
    v_max_f32 v99, 0, v99
    v_max_f32 v100, 0, v100
    v_max_f32 v101, 0, v101
    v_max_f32 v102, 0, v102
    v_max_f32 v103, 0, v103
    v_mul_f32 v96, v96, v104
    v_mul_f32 v97, v97, v105
    v_mul_f32 v98, v98, v106
    v_mul_f32 v99, v99, v107
    s_waitcnt lgkmcnt(0)
    v_mfma_f32_32x32x16_bf16 a[96:111], v[56:59], v[252:255], a[96:111]
    v_mul_f32 v100, v100, v108
    v_mul_f32 v101, v101, v109
    v_mul_f32 v102, v102, v110
    v_mul_f32 v103, v103, v111
    v_cvt_pk_bf16_f32 v112, v96, v97
    v_cvt_pk_bf16_f32 v113, v98, v99
    v_cvt_pk_bf16_f32 v114, v100, v101
    v_cvt_pk_bf16_f32 v115, v102, v103
    s_nop 1
    v_permlane32_swap_b32 v112, v114
    v_permlane32_swap_b32 v113, v115
    buffer_store_dwordx4 v[112:115], v3, s[8:11], s28 offen offset:1024 sc1
    s_nop 15
    s_nop 3
    v_accvgpr_read_b32 v96, a96
    v_accvgpr_read_b32 v97, a97
    v_accvgpr_read_b32 v98, a98
    v_accvgpr_read_b32 v99, a99
    v_accvgpr_read_b32 v100, a100
    v_accvgpr_read_b32 v101, a101
    v_accvgpr_read_b32 v102, a102
    v_accvgpr_read_b32 v103, a103
    v_accvgpr_read_b32 v104, a104
    v_accvgpr_read_b32 v105, a105
    v_accvgpr_read_b32 v106, a106
    v_accvgpr_read_b32 v107, a107
    v_accvgpr_read_b32 v108, a108
    v_accvgpr_read_b32 v109, a109
    v_accvgpr_read_b32 v110, a110
    v_accvgpr_read_b32 v111, a111
    v_max_f32 v96, 0, v96
    v_max_f32 v97, 0, v97
    v_max_f32 v98, 0, v98
    v_max_f32 v99, 0, v99
    v_max_f32 v100, 0, v100
    v_max_f32 v101, 0, v101
    v_max_f32 v102, 0, v102
    v_max_f32 v103, 0, v103
    v_mul_f32 v96, v96, v104
    v_mul_f32 v97, v97, v105
    v_mul_f32 v98, v98, v106
    v_mul_f32 v99, v99, v107
    v_mul_f32 v100, v100, v108
    v_mul_f32 v101, v101, v109
    v_mul_f32 v102, v102, v110
    v_mul_f32 v103, v103, v111
    v_cvt_pk_bf16_f32 v112, v96, v97
    v_cvt_pk_bf16_f32 v113, v98, v99
    v_cvt_pk_bf16_f32 v114, v100, v101
    v_cvt_pk_bf16_f32 v115, v102, v103
    s_nop 1
    v_permlane32_swap_b32 v112, v114
    v_permlane32_swap_b32 v113, v115
    buffer_store_dwordx4 v[112:115], v3, s[8:11], s28 offen offset:2048 sc1
k4_kernel_end:
    s_endpgm
.globl k5_kernel
.p2align 8
.type k5_kernel,@function
k5_kernel:
    s_cmp_ge_u32 s2, 256
    s_cbranch_scc1 k5_kernel_end
    s_load_dwordx2 s[16:17], s[0:1], 88
    s_load_dwordx2 s[18:19], s[0:1], 104
    s_load_dwordx2 s[12:13], s[0:1], 64
    v_lshrrev_b32 v1, 6, v0
    v_and_b32 v2, 63, v0
    s_and_b32 s20, s2, 7
    s_bfe_u32 s21, s2, 0x20003
    s_lshl_b32 s21, s21, 3
    s_add_u32 s20, s20, s21
    s_lshr_b32 s21, s2, 5
    v_readfirstlane_b32 s3, v1
    v_lshlrev_b32 v3, 4, v2
    s_waitcnt lgkmcnt(0)
    s_mov_b32 s4, s16
    s_and_b32 s5, s17, 0xffff
    s_mov_b32 s6, 2097152
    s_mov_b32 s7, 0x00020000
    s_mov_b32 s8, s18
    s_and_b32 s9, s19, 0xffff
    s_mov_b32 s10, 33554432
    s_mov_b32 s11, 0x00020000
    s_mov_b32 s36, s12
    s_and_b32 s37, s13, 0xffff
    s_mov_b32 s38, 1835008
    s_mov_b32 s39, 0x00020000
    s_lshr_b32 s22, s3, 1
    s_and_b32 s23, s3, 1
    s_lshl_b32 s24, s20, 1
    s_add_u32 s24, s24, s23
    s_lshl_b32 s24, s24, 15
    s_lshl_b32 s25, s21, 6
    s_lshl_b32 s26, s22, 5
    s_add_u32 s25, s25, s26
    v_and_b32 v4, 31, v2
    v_lshlrev_b32 v4, 10, v4
    v_lshrrev_b32 v5, 5, v2
    v_lshl_add_u32 v6, v5, 3, v4
    s_lshl_b32 s26, s25, 1
    s_add_u32 s24, s24, s26
    s_add_u32 s27, s24, 12582912
    v_lshlrev_b32 v7, 4, v5
    s_lshl_b32 s26, s25, 2
    s_add_u32 s26, s26, 141312
    v_lshrrev_b32 v60, 3, v2
    v_and_b32 v61, 7, v2
    v_bfe_u32 v62, v2, 4, 1
    v_lshlrev_b32 v62, 2, v62
    v_xor_b32 v61, v61, v62
    v_lshlrev_b32 v60, 10, v60
    v_lshl_add_u32 v63, v61, 4, v60
    s_mul_i32 s30, s3, 458752
    s_lshl_b32 s28, s21, 7
    s_add_u32 s30, s30, s28
    s_mul_i32 s31, s3, 20480
    s_mul_i32 s28, s3, 28672
    s_mul_i32 s32, s20, 229376
    s_add_u32 s32, s32, s28
    s_add_u32 s32, s32, 16777216
    s_add_u32 s33, s32, 114688
    v_lshrrev_b32 v56, 4, v2
    v_and_b32 v57, 15, v2
    v_and_b32 v58, 1, v56
    v_lshrrev_b32 v59, 1, v56
    v_lshrrev_b32 v60, 2, v57
    v_lshl_add_u32 v60, v59, 3, v60
    v_lshlrev_b32 v60, 7, v60
    v_lshl_add_u32 v60, v58, 5, v60
    v_and_b32 v61, 3, v57
    v_lshl_add_u32 v60, v61, 3, v60
    v_add_u32 v60, s31, v60
    v_bfe_u32 v61, v57, 3, 1
    v_lshl_add_u32 v64, v61, 6, v60
    v_xor_b32 v61, 1, v61
    v_lshl_add_u32 v65, v61, 6, v60
    s_add_u32 s28, s31, 0
    s_mov_b32 m0, s28
    s_add_u32 s29, s30, 0
    buffer_load_dwordx4 v63, s[36:39], s29 offen lds
    s_add_u32 s28, s31, 1024
    s_mov_b32 m0, s28
    s_add_u32 s29, s30, 8192
    buffer_load_dwordx4 v63, s[36:39], s29 offen lds
    s_add_u32 s29, s32, 0
    buffer_load_dwordx4 v[96:99], v3, s[8:11], s29 offen offset:0
    s_add_u32 s29, s33, 0
    buffer_load_dwordx4 v[100:103], v3, s[8:11], s29 offen offset:0
    s_add_u32 s28, s31, 2048
    s_mov_b32 m0, s28
    s_add_u32 s29, s30, 16384
    buffer_load_dwordx4 v63, s[36:39], s29 offen lds
    s_add_u32 s28, s31, 3072
    s_mov_b32 m0, s28
    s_add_u32 s29, s30, 24576
    buffer_load_dwordx4 v63, s[36:39], s29 offen lds
    s_add_u32 s29, s32, 0
    buffer_load_dwordx4 v[104:107], v3, s[8:11], s29 offen offset:1024
    s_add_u32 s29, s33, 0
    buffer_load_dwordx4 v[108:111], v3, s[8:11], s29 offen offset:1024
    s_add_u32 s28, s31, 4096
    s_mov_b32 m0, s28
    s_add_u32 s29, s30, 32768
    buffer_load_dwordx4 v63, s[36:39], s29 offen lds
    s_add_u32 s28, s31, 5120
    s_mov_b32 m0, s28
    s_add_u32 s29, s30, 40960
    buffer_load_dwordx4 v63, s[36:39], s29 offen lds
    s_add_u32 s29, s32, 0
    buffer_load_dwordx4 v[112:115], v3, s[8:11], s29 offen offset:2048
    s_add_u32 s29, s33, 0
    buffer_load_dwordx4 v[116:119], v3, s[8:11], s29 offen offset:2048
    s_waitcnt vmcnt(8)
    ds_read_b64_tr_b16 v[72:73], v64 offset:0
    ds_read_b64_tr_b16 v[74:75], v64 offset:512
    ds_read_b64_tr_b16 v[76:77], v65 offset:0
    ds_read_b64_tr_b16 v[78:79], v65 offset:512
    s_waitcnt vmcnt(4)
    ds_read_b64_tr_b16 v[80:81], v64 offset:2048
    ds_read_b64_tr_b16 v[82:83], v64 offset:2560
    ds_read_b64_tr_b16 v[84:85], v65 offset:2048
    ds_read_b64_tr_b16 v[86:87], v65 offset:2560
    s_waitcnt lgkmcnt(4)
    v_mfma_f32_32x32x16_bf16 a[0:15], v[72:75], v[96:99], 0
    s_add_u32 s28, s31, 6144
    s_mov_b32 m0, s28
    s_add_u32 s29, s30, 49152
    buffer_load_dwordx4 v63, s[36:39], s29 offen lds
    s_add_u32 s28, s31, 7168
    s_mov_b32 m0, s28
    s_add_u32 s29, s30, 57344
    buffer_load_dwordx4 v63, s[36:39], s29 offen lds
    v_mfma_f32_32x32x16_bf16 a[16:31], v[72:75], v[100:103], 0
    s_add_u32 s29, s32, 0
    buffer_load_dwordx4 v[120:123], v3, s[8:11], s29 offen offset:3072
    s_add_u32 s29, s33, 0
    buffer_load_dwordx4 v[124:127], v3, s[8:11], s29 offen offset:3072
    v_mfma_f32_32x32x16_bf16 a[32:47], v[76:79], v[96:99], 0
    s_add_u32 s28, s31, 8192
    s_mov_b32 m0, s28
    s_add_u32 s29, s30, 65536
    buffer_load_dwordx4 v63, s[36:39], s29 offen lds
    s_add_u32 s28, s31, 9216
    s_mov_b32 m0, s28
    s_add_u32 s29, s30, 73728
    buffer_load_dwordx4 v63, s[36:39], s29 offen lds
    v_mfma_f32_32x32x16_bf16 a[48:63], v[76:79], v[100:103], 0
    s_add_u32 s29, s32, 4096
    buffer_load_dwordx4 v[128:131], v3, s[8:11], s29 offen offset:0
    s_add_u32 s29, s33, 4096
    buffer_load_dwordx4 v[132:135], v3, s[8:11], s29 offen offset:0
    s_waitcnt vmcnt(8)
    ds_read_b64_tr_b16 v[72:73], v64 offset:4096
    ds_read_b64_tr_b16 v[74:75], v64 offset:4608
    ds_read_b64_tr_b16 v[76:77], v65 offset:4096
    ds_read_b64_tr_b16 v[78:79], v65 offset:4608
    s_waitcnt lgkmcnt(4)
    v_mfma_f32_32x32x16_bf16 a[0:15], v[80:83], v[104:107], a[0:15]
    s_add_u32 s28, s31, 10240
    s_mov_b32 m0, s28
    s_add_u32 s29, s30, 81920
    buffer_load_dwordx4 v63, s[36:39], s29 offen lds
    s_add_u32 s28, s31, 11264
    s_mov_b32 m0, s28
    s_add_u32 s29, s30, 90112
    buffer_load_dwordx4 v63, s[36:39], s29 offen lds
    v_mfma_f32_32x32x16_bf16 a[16:31], v[80:83], v[108:111], a[16:31]
    s_add_u32 s29, s32, 4096
    buffer_load_dwordx4 v[136:139], v3, s[8:11], s29 offen offset:1024
    s_add_u32 s29, s33, 4096
    buffer_load_dwordx4 v[140:143], v3, s[8:11], s29 offen offset:1024
    v_mfma_f32_32x32x16_bf16 a[32:47], v[84:87], v[104:107], a[32:47]
    s_add_u32 s28, s31, 12288
    s_mov_b32 m0, s28
    s_add_u32 s29, s30, 98304
    buffer_load_dwordx4 v63, s[36:39], s29 offen lds
    s_add_u32 s28, s31, 13312
    s_mov_b32 m0, s28
    s_add_u32 s29, s30, 106496
    buffer_load_dwordx4 v63, s[36:39], s29 offen lds
    v_mfma_f32_32x32x16_bf16 a[48:63], v[84:87], v[108:111], a[48:63]
    s_add_u32 s29, s32, 4096
    buffer_load_dwordx4 v[144:147], v3, s[8:11], s29 offen offset:2048
    s_add_u32 s29, s33, 4096
    buffer_load_dwordx4 v[148:151], v3, s[8:11], s29 offen offset:2048
    s_waitcnt vmcnt(12)
    ds_read_b64_tr_b16 v[80:81], v64 offset:6144
    ds_read_b64_tr_b16 v[82:83], v64 offset:6656
    ds_read_b64_tr_b16 v[84:85], v65 offset:6144
    ds_read_b64_tr_b16 v[86:87], v65 offset:6656
    s_waitcnt lgkmcnt(4)
    v_mfma_f32_32x32x16_bf16 a[0:15], v[72:75], v[112:115], a[0:15]
    s_add_u32 s28, s31, 14336
    s_mov_b32 m0, s28
    s_add_u32 s29, s30, 114688
    buffer_load_dwordx4 v63, s[36:39], s29 offen lds
    s_add_u32 s28, s31, 15360
    s_mov_b32 m0, s28
    s_add_u32 s29, s30, 122880
    buffer_load_dwordx4 v63, s[36:39], s29 offen lds
    v_mfma_f32_32x32x16_bf16 a[16:31], v[72:75], v[116:119], a[16:31]
    s_add_u32 s29, s32, 4096
    buffer_load_dwordx4 v[152:155], v3, s[8:11], s29 offen offset:3072
    s_add_u32 s29, s33, 4096
    buffer_load_dwordx4 v[156:159], v3, s[8:11], s29 offen offset:3072
    v_mfma_f32_32x32x16_bf16 a[32:47], v[76:79], v[112:115], a[32:47]
    s_add_u32 s28, s31, 16384
    s_mov_b32 m0, s28
    s_add_u32 s29, s30, 131072
    buffer_load_dwordx4 v63, s[36:39], s29 offen lds
    s_add_u32 s28, s31, 17408
    s_mov_b32 m0, s28
    s_add_u32 s29, s30, 139264
    buffer_load_dwordx4 v63, s[36:39], s29 offen lds
    v_mfma_f32_32x32x16_bf16 a[48:63], v[76:79], v[116:119], a[48:63]
    s_add_u32 s29, s32, 8192
    buffer_load_dwordx4 v[160:163], v3, s[8:11], s29 offen offset:0
    s_add_u32 s29, s33, 8192
    buffer_load_dwordx4 v[164:167], v3, s[8:11], s29 offen offset:0
    s_waitcnt vmcnt(16)
    ds_read_b64_tr_b16 v[72:73], v64 offset:8192
    ds_read_b64_tr_b16 v[74:75], v64 offset:8704
    ds_read_b64_tr_b16 v[76:77], v65 offset:8192
    ds_read_b64_tr_b16 v[78:79], v65 offset:8704
    s_waitcnt lgkmcnt(4)
    v_mfma_f32_32x32x16_bf16 a[0:15], v[80:83], v[120:123], a[0:15]
    s_add_u32 s28, s31, 18432
    s_mov_b32 m0, s28
    s_add_u32 s29, s30, 147456
    buffer_load_dwordx4 v63, s[36:39], s29 offen lds
    s_add_u32 s28, s31, 19456
    s_mov_b32 m0, s28
    s_add_u32 s29, s30, 155648
    buffer_load_dwordx4 v63, s[36:39], s29 offen lds
    v_mfma_f32_32x32x16_bf16 a[16:31], v[80:83], v[124:127], a[16:31]
    s_add_u32 s29, s32, 8192
    buffer_load_dwordx4 v[168:171], v3, s[8:11], s29 offen offset:1024
    s_add_u32 s29, s33, 8192
    buffer_load_dwordx4 v[172:175], v3, s[8:11], s29 offen offset:1024
    v_mfma_f32_32x32x16_bf16 a[32:47], v[84:87], v[120:123], a[32:47]
    s_add_u32 s28, s31, 0
    s_mov_b32 m0, s28
    s_add_u32 s29, s30, 163840
    buffer_load_dwordx4 v63, s[36:39], s29 offen lds
    s_add_u32 s28, s31, 1024
    s_mov_b32 m0, s28
    s_add_u32 s29, s30, 172032
    buffer_load_dwordx4 v63, s[36:39], s29 offen lds
    v_mfma_f32_32x32x16_bf16 a[48:63], v[84:87], v[124:127], a[48:63]
    s_add_u32 s29, s32, 8192
    buffer_load_dwordx4 v[96:99], v3, s[8:11], s29 offen offset:2048
    s_add_u32 s29, s33, 8192
    buffer_load_dwordx4 v[100:103], v3, s[8:11], s29 offen offset:2048
    s_waitcnt vmcnt(20)
    ds_read_b64_tr_b16 v[80:81], v64 offset:10240
    ds_read_b64_tr_b16 v[82:83], v64 offset:10752
    ds_read_b64_tr_b16 v[84:85], v65 offset:10240
    ds_read_b64_tr_b16 v[86:87], v65 offset:10752
    s_waitcnt lgkmcnt(4)
    v_mfma_f32_32x32x16_bf16 a[0:15], v[72:75], v[128:131], a[0:15]
    s_add_u32 s28, s31, 2048
    s_mov_b32 m0, s28
    s_add_u32 s29, s30, 180224
    buffer_load_dwordx4 v63, s[36:39], s29 offen lds
    s_add_u32 s28, s31, 3072
    s_mov_b32 m0, s28
    s_add_u32 s29, s30, 188416
    buffer_load_dwordx4 v63, s[36:39], s29 offen lds
    v_mfma_f32_32x32x16_bf16 a[16:31], v[72:75], v[132:135], a[16:31]
    s_add_u32 s29, s32, 8192
    buffer_load_dwordx4 v[104:107], v3, s[8:11], s29 offen offset:3072
    s_add_u32 s29, s33, 8192
    buffer_load_dwordx4 v[108:111], v3, s[8:11], s29 offen offset:3072
    v_mfma_f32_32x32x16_bf16 a[32:47], v[76:79], v[128:131], a[32:47]
    s_add_u32 s28, s31, 4096
    s_mov_b32 m0, s28
    s_add_u32 s29, s30, 196608
    buffer_load_dwordx4 v63, s[36:39], s29 offen lds
    s_add_u32 s28, s31, 5120
    s_mov_b32 m0, s28
    s_add_u32 s29, s30, 204800
    buffer_load_dwordx4 v63, s[36:39], s29 offen lds
    v_mfma_f32_32x32x16_bf16 a[48:63], v[76:79], v[132:135], a[48:63]
    s_add_u32 s29, s32, 12288
    buffer_load_dwordx4 v[112:115], v3, s[8:11], s29 offen offset:0
    s_add_u32 s29, s33, 12288
    buffer_load_dwordx4 v[116:119], v3, s[8:11], s29 offen offset:0
    s_waitcnt vmcnt(24)
    ds_read_b64_tr_b16 v[72:73], v64 offset:12288
    ds_read_b64_tr_b16 v[74:75], v64 offset:12800
    ds_read_b64_tr_b16 v[76:77], v65 offset:12288
    ds_read_b64_tr_b16 v[78:79], v65 offset:12800
    s_waitcnt lgkmcnt(4)
    v_mfma_f32_32x32x16_bf16 a[0:15], v[80:83], v[136:139], a[0:15]
    s_add_u32 s28, s31, 6144
    s_mov_b32 m0, s28
    s_add_u32 s29, s30, 212992
    buffer_load_dwordx4 v63, s[36:39], s29 offen lds
    s_add_u32 s28, s31, 7168
    s_mov_b32 m0, s28
    s_add_u32 s29, s30, 221184
    buffer_load_dwordx4 v63, s[36:39], s29 offen lds
    v_mfma_f32_32x32x16_bf16 a[16:31], v[80:83], v[140:143], a[16:31]
    s_add_u32 s29, s32, 12288
    buffer_load_dwordx4 v[120:123], v3, s[8:11], s29 offen offset:1024
    s_add_u32 s29, s33, 12288
    buffer_load_dwordx4 v[124:127], v3, s[8:11], s29 offen offset:1024
    v_mfma_f32_32x32x16_bf16 a[32:47], v[84:87], v[136:139], a[32:47]
    s_add_u32 s28, s31, 8192
    s_mov_b32 m0, s28
    s_add_u32 s29, s30, 229376
    buffer_load_dwordx4 v63, s[36:39], s29 offen lds
    s_add_u32 s28, s31, 9216
    s_mov_b32 m0, s28
    s_add_u32 s29, s30, 237568
    buffer_load_dwordx4 v63, s[36:39], s29 offen lds
    v_mfma_f32_32x32x16_bf16 a[48:63], v[84:87], v[140:143], a[48:63]
    s_add_u32 s29, s32, 12288
    buffer_load_dwordx4 v[128:131], v3, s[8:11], s29 offen offset:2048
    s_add_u32 s29, s33, 12288
    buffer_load_dwordx4 v[132:135], v3, s[8:11], s29 offen offset:2048
    s_waitcnt vmcnt(28)
    ds_read_b64_tr_b16 v[80:81], v64 offset:14336
    ds_read_b64_tr_b16 v[82:83], v64 offset:14848
    ds_read_b64_tr_b16 v[84:85], v65 offset:14336
    ds_read_b64_tr_b16 v[86:87], v65 offset:14848
    s_waitcnt lgkmcnt(4)
    v_mfma_f32_32x32x16_bf16 a[0:15], v[72:75], v[144:147], a[0:15]
    buffer_load_dwordx2 v[8:9], v6, s[8:11], s27 offen offset:0
    buffer_load_dwordx2 v[10:11], v6, s[8:11], s27 offen offset:16
    v_mfma_f32_32x32x16_bf16 a[16:31], v[72:75], v[148:151], a[16:31]
    buffer_load_dwordx2 v[12:13], v6, s[8:11], s27 offen offset:32
    buffer_load_dwordx2 v[14:15], v6, s[8:11], s27 offen offset:48
    v_mfma_f32_32x32x16_bf16 a[32:47], v[76:79], v[144:147], a[32:47]
    buffer_load_dwordx4 v[240:243], v7, s[8:11], s26 offen offset:0
    buffer_load_dwordx4 v[244:247], v7, s[8:11], s26 offen offset:32
    v_mfma_f32_32x32x16_bf16 a[48:63], v[76:79], v[148:151], a[48:63]
    buffer_load_dwordx4 v[248:251], v7, s[8:11], s26 offen offset:64
    buffer_load_dwordx4 v[252:255], v7, s[8:11], s26 offen offset:96
    s_waitcnt vmcnt(32)
    ds_read_b64_tr_b16 v[72:73], v64 offset:16384
    ds_read_b64_tr_b16 v[74:75], v64 offset:16896
    ds_read_b64_tr_b16 v[76:77], v65 offset:16384
    ds_read_b64_tr_b16 v[78:79], v65 offset:16896
    s_waitcnt lgkmcnt(4)
    v_mfma_f32_32x32x16_bf16 a[0:15], v[80:83], v[152:155], a[0:15]
    s_add_u32 s28, s31, 10240
    s_mov_b32 m0, s28
    s_add_u32 s29, s30, 245760
    buffer_load_dwordx4 v63, s[36:39], s29 offen lds
    s_add_u32 s28, s31, 11264
    s_mov_b32 m0, s28
    s_add_u32 s29, s30, 253952
    buffer_load_dwordx4 v63, s[36:39], s29 offen lds
    v_mfma_f32_32x32x16_bf16 a[16:31], v[80:83], v[156:159], a[16:31]
    s_add_u32 s29, s32, 12288
    buffer_load_dwordx4 v[136:139], v3, s[8:11], s29 offen offset:3072
    s_add_u32 s29, s33, 12288
    buffer_load_dwordx4 v[140:143], v3, s[8:11], s29 offen offset:3072
    v_mfma_f32_32x32x16_bf16 a[32:47], v[84:87], v[152:155], a[32:47]
    s_add_u32 s28, s31, 12288
    s_mov_b32 m0, s28
    s_add_u32 s29, s30, 262144
    buffer_load_dwordx4 v63, s[36:39], s29 offen lds
    s_add_u32 s28, s31, 13312
    s_mov_b32 m0, s28
    s_add_u32 s29, s30, 270336
    buffer_load_dwordx4 v63, s[36:39], s29 offen lds
    v_mfma_f32_32x32x16_bf16 a[48:63], v[84:87], v[156:159], a[48:63]
    s_add_u32 s29, s32, 16384
    buffer_load_dwordx4 v[144:147], v3, s[8:11], s29 offen offset:0
    s_add_u32 s29, s33, 16384
    buffer_load_dwordx4 v[148:151], v3, s[8:11], s29 offen offset:0
    s_waitcnt vmcnt(36)
    ds_read_b64_tr_b16 v[80:81], v64 offset:18432
    ds_read_b64_tr_b16 v[82:83], v64 offset:18944
    ds_read_b64_tr_b16 v[84:85], v65 offset:18432
    ds_read_b64_tr_b16 v[86:87], v65 offset:18944
    s_waitcnt lgkmcnt(4)
    v_mfma_f32_32x32x16_bf16 a[0:15], v[72:75], v[160:163], a[0:15]
    s_add_u32 s28, s31, 14336
    s_mov_b32 m0, s28
    s_add_u32 s29, s30, 278528
    buffer_load_dwordx4 v63, s[36:39], s29 offen lds
    s_add_u32 s28, s31, 15360
    s_mov_b32 m0, s28
    s_add_u32 s29, s30, 286720
    buffer_load_dwordx4 v63, s[36:39], s29 offen lds
    v_mfma_f32_32x32x16_bf16 a[16:31], v[72:75], v[164:167], a[16:31]
    s_add_u32 s29, s32, 16384
    buffer_load_dwordx4 v[152:155], v3, s[8:11], s29 offen offset:1024
    s_add_u32 s29, s33, 16384
    buffer_load_dwordx4 v[156:159], v3, s[8:11], s29 offen offset:1024
    v_mfma_f32_32x32x16_bf16 a[32:47], v[76:79], v[160:163], a[32:47]
    s_add_u32 s28, s31, 16384
    s_mov_b32 m0, s28
    s_add_u32 s29, s30, 294912
    buffer_load_dwordx4 v63, s[36:39], s29 offen lds
    s_add_u32 s28, s31, 17408
    s_mov_b32 m0, s28
    s_add_u32 s29, s30, 303104
    buffer_load_dwordx4 v63, s[36:39], s29 offen lds
    v_mfma_f32_32x32x16_bf16 a[48:63], v[76:79], v[164:167], a[48:63]
    s_add_u32 s29, s32, 16384
    buffer_load_dwordx4 v[160:163], v3, s[8:11], s29 offen offset:2048
    s_add_u32 s29, s33, 16384
    buffer_load_dwordx4 v[164:167], v3, s[8:11], s29 offen offset:2048
    s_waitcnt vmcnt(40)
    ds_read_b64_tr_b16 v[72:73], v64 offset:0
    ds_read_b64_tr_b16 v[74:75], v64 offset:512
    ds_read_b64_tr_b16 v[76:77], v65 offset:0
    ds_read_b64_tr_b16 v[78:79], v65 offset:512
    s_waitcnt lgkmcnt(4)
    v_mfma_f32_32x32x16_bf16 a[0:15], v[80:83], v[168:171], a[0:15]
    s_add_u32 s28, s31, 18432
    s_mov_b32 m0, s28
    s_add_u32 s29, s30, 311296
    buffer_load_dwordx4 v63, s[36:39], s29 offen lds
    s_add_u32 s28, s31, 19456
    s_mov_b32 m0, s28
    s_add_u32 s29, s30, 319488
    buffer_load_dwordx4 v63, s[36:39], s29 offen lds
    v_mfma_f32_32x32x16_bf16 a[16:31], v[80:83], v[172:175], a[16:31]
    v_mfma_f32_32x32x16_bf16 a[32:47], v[84:87], v[168:171], a[32:47]
    s_add_u32 s29, s32, 16384
    buffer_load_dwordx4 v[168:171], v3, s[8:11], s29 offen offset:3072
    v_mfma_f32_32x32x16_bf16 a[48:63], v[84:87], v[172:175], a[48:63]
    s_add_u32 s29, s33, 16384
    buffer_load_dwordx4 v[172:175], v3, s[8:11], s29 offen offset:3072
    s_waitcnt vmcnt(40)
    ds_read_b64_tr_b16 v[80:81], v64 offset:2048
    ds_read_b64_tr_b16 v[82:83], v64 offset:2560
    ds_read_b64_tr_b16 v[84:85], v65 offset:2048
    ds_read_b64_tr_b16 v[86:87], v65 offset:2560
    s_waitcnt lgkmcnt(4)
    v_mfma_f32_32x32x16_bf16 a[0:15], v[72:75], v[96:99], a[0:15]
    s_add_u32 s28, s31, 0
    s_mov_b32 m0, s28
    s_add_u32 s29, s30, 327680
    buffer_load_dwordx4 v63, s[36:39], s29 offen lds
    s_add_u32 s28, s31, 1024
    s_mov_b32 m0, s28
    s_add_u32 s29, s30, 335872
    buffer_load_dwordx4 v63, s[36:39], s29 offen lds
    v_mfma_f32_32x32x16_bf16 a[16:31], v[72:75], v[100:103], a[16:31]
    v_mfma_f32_32x32x16_bf16 a[32:47], v[76:79], v[96:99], a[32:47]
    s_add_u32 s29, s32, 20480
    buffer_load_dwordx4 v[96:99], v3, s[8:11], s29 offen offset:0
    v_mfma_f32_32x32x16_bf16 a[48:63], v[76:79], v[100:103], a[48:63]
    s_add_u32 s29, s33, 20480
    buffer_load_dwordx4 v[100:103], v3, s[8:11], s29 offen offset:0
    s_waitcnt vmcnt(40)
    ds_read_b64_tr_b16 v[72:73], v64 offset:4096
    ds_read_b64_tr_b16 v[74:75], v64 offset:4608
    ds_read_b64_tr_b16 v[76:77], v65 offset:4096
    ds_read_b64_tr_b16 v[78:79], v65 offset:4608
    s_waitcnt lgkmcnt(4)
    v_mfma_f32_32x32x16_bf16 a[0:15], v[80:83], v[104:107], a[0:15]
    s_add_u32 s28, s31, 2048
    s_mov_b32 m0, s28
    s_add_u32 s29, s30, 344064
    buffer_load_dwordx4 v63, s[36:39], s29 offen lds
    s_add_u32 s28, s31, 3072
    s_mov_b32 m0, s28
    s_add_u32 s29, s30, 352256
    buffer_load_dwordx4 v63, s[36:39], s29 offen lds
    v_mfma_f32_32x32x16_bf16 a[16:31], v[80:83], v[108:111], a[16:31]
    v_mfma_f32_32x32x16_bf16 a[32:47], v[84:87], v[104:107], a[32:47]
    s_add_u32 s29, s32, 20480
    buffer_load_dwordx4 v[104:107], v3, s[8:11], s29 offen offset:1024
    v_mfma_f32_32x32x16_bf16 a[48:63], v[84:87], v[108:111], a[48:63]
    s_add_u32 s29, s33, 20480
    buffer_load_dwordx4 v[108:111], v3, s[8:11], s29 offen offset:1024
    s_waitcnt vmcnt(40)
    ds_read_b64_tr_b16 v[80:81], v64 offset:6144
    ds_read_b64_tr_b16 v[82:83], v64 offset:6656
    ds_read_b64_tr_b16 v[84:85], v65 offset:6144
    ds_read_b64_tr_b16 v[86:87], v65 offset:6656
    s_waitcnt lgkmcnt(4)
    v_mfma_f32_32x32x16_bf16 a[0:15], v[72:75], v[112:115], a[0:15]
    s_add_u32 s28, s31, 4096
    s_mov_b32 m0, s28
    s_add_u32 s29, s30, 360448
    buffer_load_dwordx4 v63, s[36:39], s29 offen lds
    v_mfma_f32_32x32x16_bf16 a[16:31], v[72:75], v[116:119], a[16:31]
    s_add_u32 s28, s31, 5120
    s_mov_b32 m0, s28
    s_add_u32 s29, s30, 368640
    buffer_load_dwordx4 v63, s[36:39], s29 offen lds
    v_mfma_f32_32x32x16_bf16 a[32:47], v[76:79], v[112:115], a[32:47]
    s_add_u32 s29, s32, 20480
    buffer_load_dwordx4 v[112:115], v3, s[8:11], s29 offen offset:2048
    v_mfma_f32_32x32x16_bf16 a[48:63], v[76:79], v[116:119], a[48:63]
    s_add_u32 s29, s33, 20480
    buffer_load_dwordx4 v[116:119], v3, s[8:11], s29 offen offset:2048
    s_waitcnt vmcnt(40)
    ds_read_b64_tr_b16 v[72:73], v64 offset:8192
    ds_read_b64_tr_b16 v[74:75], v64 offset:8704
    ds_read_b64_tr_b16 v[76:77], v65 offset:8192
    ds_read_b64_tr_b16 v[78:79], v65 offset:8704
    s_waitcnt lgkmcnt(4)
    v_mfma_f32_32x32x16_bf16 a[0:15], v[80:83], v[120:123], a[0:15]
    s_add_u32 s28, s31, 6144
    s_mov_b32 m0, s28
    s_add_u32 s29, s30, 376832
    buffer_load_dwordx4 v63, s[36:39], s29 offen lds
    v_mfma_f32_32x32x16_bf16 a[16:31], v[80:83], v[124:127], a[16:31]
    s_add_u32 s28, s31, 7168
    s_mov_b32 m0, s28
    s_add_u32 s29, s30, 385024
    buffer_load_dwordx4 v63, s[36:39], s29 offen lds
    v_mfma_f32_32x32x16_bf16 a[32:47], v[84:87], v[120:123], a[32:47]
    s_add_u32 s29, s32, 20480
    buffer_load_dwordx4 v[120:123], v3, s[8:11], s29 offen offset:3072
    v_mfma_f32_32x32x16_bf16 a[48:63], v[84:87], v[124:127], a[48:63]
    s_add_u32 s29, s33, 20480
    buffer_load_dwordx4 v[124:127], v3, s[8:11], s29 offen offset:3072
    s_waitcnt vmcnt(32)
    ds_read_b64_tr_b16 v[80:81], v64 offset:10240
    ds_read_b64_tr_b16 v[82:83], v64 offset:10752
    ds_read_b64_tr_b16 v[84:85], v65 offset:10240
    ds_read_b64_tr_b16 v[86:87], v65 offset:10752
    s_waitcnt lgkmcnt(4)
    v_mfma_f32_32x32x16_bf16 a[0:15], v[72:75], v[128:131], a[0:15]
    s_add_u32 s28, s31, 8192
    s_mov_b32 m0, s28
    s_add_u32 s29, s30, 393216
    buffer_load_dwordx4 v63, s[36:39], s29 offen lds
    v_mfma_f32_32x32x16_bf16 a[16:31], v[72:75], v[132:135], a[16:31]
    s_add_u32 s28, s31, 9216
    s_mov_b32 m0, s28
    s_add_u32 s29, s30, 401408
    buffer_load_dwordx4 v63, s[36:39], s29 offen lds
    v_mfma_f32_32x32x16_bf16 a[32:47], v[76:79], v[128:131], a[32:47]
    s_add_u32 s29, s32, 24576
    buffer_load_dwordx4 v[128:131], v3, s[8:11], s29 offen offset:0
    v_mfma_f32_32x32x16_bf16 a[48:63], v[76:79], v[132:135], a[48:63]
    s_add_u32 s29, s33, 24576
    buffer_load_dwordx4 v[132:135], v3, s[8:11], s29 offen offset:0
    s_waitcnt vmcnt(32)
    ds_read_b64_tr_b16 v[72:73], v64 offset:12288
    ds_read_b64_tr_b16 v[74:75], v64 offset:12800
    ds_read_b64_tr_b16 v[76:77], v65 offset:12288
    ds_read_b64_tr_b16 v[78:79], v65 offset:12800
    s_waitcnt lgkmcnt(4)
    v_mfma_f32_32x32x16_bf16 a[0:15], v[80:83], v[136:139], a[0:15]
    s_add_u32 s28, s31, 10240
    s_mov_b32 m0, s28
    s_add_u32 s29, s30, 409600
    buffer_load_dwordx4 v63, s[36:39], s29 offen lds
    v_mfma_f32_32x32x16_bf16 a[16:31], v[80:83], v[140:143], a[16:31]
    s_add_u32 s28, s31, 11264
    s_mov_b32 m0, s28
    s_add_u32 s29, s30, 417792
    buffer_load_dwordx4 v63, s[36:39], s29 offen lds
    v_mfma_f32_32x32x16_bf16 a[32:47], v[84:87], v[136:139], a[32:47]
    s_add_u32 s29, s32, 24576
    buffer_load_dwordx4 v[136:139], v3, s[8:11], s29 offen offset:1024
    v_mfma_f32_32x32x16_bf16 a[48:63], v[84:87], v[140:143], a[48:63]
    s_add_u32 s29, s33, 24576
    buffer_load_dwordx4 v[140:143], v3, s[8:11], s29 offen offset:1024
    s_waitcnt vmcnt(32)
    ds_read_b64_tr_b16 v[80:81], v64 offset:14336
    ds_read_b64_tr_b16 v[82:83], v64 offset:14848
    ds_read_b64_tr_b16 v[84:85], v65 offset:14336
    ds_read_b64_tr_b16 v[86:87], v65 offset:14848
    s_waitcnt lgkmcnt(4)
    v_mfma_f32_32x32x16_bf16 a[0:15], v[72:75], v[144:147], a[0:15]
    s_add_u32 s28, s31, 12288
    s_mov_b32 m0, s28
    s_add_u32 s29, s30, 425984
    buffer_load_dwordx4 v63, s[36:39], s29 offen lds
    v_mfma_f32_32x32x16_bf16 a[16:31], v[72:75], v[148:151], a[16:31]
    s_add_u32 s28, s31, 13312
    s_mov_b32 m0, s28
    s_add_u32 s29, s30, 434176
    buffer_load_dwordx4 v63, s[36:39], s29 offen lds
    v_mfma_f32_32x32x16_bf16 a[32:47], v[76:79], v[144:147], a[32:47]
    s_add_u32 s29, s32, 24576
    buffer_load_dwordx4 v[144:147], v3, s[8:11], s29 offen offset:2048
    v_mfma_f32_32x32x16_bf16 a[48:63], v[76:79], v[148:151], a[48:63]
    s_add_u32 s29, s33, 24576
    buffer_load_dwordx4 v[148:151], v3, s[8:11], s29 offen offset:2048
    s_waitcnt vmcnt(32)
    ds_read_b64_tr_b16 v[72:73], v64 offset:16384
    ds_read_b64_tr_b16 v[74:75], v64 offset:16896
    ds_read_b64_tr_b16 v[76:77], v65 offset:16384
    ds_read_b64_tr_b16 v[78:79], v65 offset:16896
    s_waitcnt lgkmcnt(4)
    v_mfma_f32_32x32x16_bf16 a[0:15], v[80:83], v[152:155], a[0:15]
    s_add_u32 s28, s31, 14336
    s_mov_b32 m0, s28
    s_add_u32 s29, s30, 442368
    buffer_load_dwordx4 v63, s[36:39], s29 offen lds
    v_mfma_f32_32x32x16_bf16 a[16:31], v[80:83], v[156:159], a[16:31]
    s_add_u32 s28, s31, 15360
    s_mov_b32 m0, s28
    s_add_u32 s29, s30, 450560
    buffer_load_dwordx4 v63, s[36:39], s29 offen lds
    v_mfma_f32_32x32x16_bf16 a[32:47], v[84:87], v[152:155], a[32:47]
    s_add_u32 s29, s32, 24576
    buffer_load_dwordx4 v[152:155], v3, s[8:11], s29 offen offset:3072
    v_mfma_f32_32x32x16_bf16 a[48:63], v[84:87], v[156:159], a[48:63]
    s_add_u32 s29, s33, 24576
    buffer_load_dwordx4 v[156:159], v3, s[8:11], s29 offen offset:3072
    s_waitcnt vmcnt(32)
    ds_read_b64_tr_b16 v[80:81], v64 offset:18432
    ds_read_b64_tr_b16 v[82:83], v64 offset:18944
    ds_read_b64_tr_b16 v[84:85], v65 offset:18432
    ds_read_b64_tr_b16 v[86:87], v65 offset:18944
    s_waitcnt lgkmcnt(4)
    v_mfma_f32_32x32x16_bf16 a[0:15], v[72:75], v[160:163], a[0:15]
    v_mfma_f32_32x32x16_bf16 a[16:31], v[72:75], v[164:167], a[16:31]
    v_mfma_f32_32x32x16_bf16 a[32:47], v[76:79], v[160:163], a[32:47]
    v_mfma_f32_32x32x16_bf16 a[48:63], v[76:79], v[164:167], a[48:63]
    s_waitcnt vmcnt(28)
    ds_read_b64_tr_b16 v[72:73], v64 offset:0
    ds_read_b64_tr_b16 v[74:75], v64 offset:512
    ds_read_b64_tr_b16 v[76:77], v65 offset:0
    ds_read_b64_tr_b16 v[78:79], v65 offset:512
    s_waitcnt lgkmcnt(4)
    v_mfma_f32_32x32x16_bf16 a[0:15], v[80:83], v[168:171], a[0:15]
    v_mfma_f32_32x32x16_bf16 a[16:31], v[80:83], v[172:175], a[16:31]
    v_mfma_f32_32x32x16_bf16 a[32:47], v[84:87], v[168:171], a[32:47]
    v_mfma_f32_32x32x16_bf16 a[48:63], v[84:87], v[172:175], a[48:63]
    s_waitcnt vmcnt(24)
    ds_read_b64_tr_b16 v[80:81], v64 offset:2048
    ds_read_b64_tr_b16 v[82:83], v64 offset:2560
    ds_read_b64_tr_b16 v[84:85], v65 offset:2048
    ds_read_b64_tr_b16 v[86:87], v65 offset:2560
    s_waitcnt lgkmcnt(4)
    v_mfma_f32_32x32x16_bf16 a[0:15], v[72:75], v[96:99], a[0:15]
    v_mfma_f32_32x32x16_bf16 a[16:31], v[72:75], v[100:103], a[16:31]
    v_mfma_f32_32x32x16_bf16 a[32:47], v[76:79], v[96:99], a[32:47]
    v_mfma_f32_32x32x16_bf16 a[48:63], v[76:79], v[100:103], a[48:63]
    s_waitcnt vmcnt(20)
    ds_read_b64_tr_b16 v[72:73], v64 offset:4096
    ds_read_b64_tr_b16 v[74:75], v64 offset:4608
    ds_read_b64_tr_b16 v[76:77], v65 offset:4096
    ds_read_b64_tr_b16 v[78:79], v65 offset:4608
    s_waitcnt lgkmcnt(4)
    v_mfma_f32_32x32x16_bf16 a[0:15], v[80:83], v[104:107], a[0:15]
    v_mfma_f32_32x32x16_bf16 a[16:31], v[80:83], v[108:111], a[16:31]
    v_mfma_f32_32x32x16_bf16 a[32:47], v[84:87], v[104:107], a[32:47]
    v_mfma_f32_32x32x16_bf16 a[48:63], v[84:87], v[108:111], a[48:63]
    s_waitcnt vmcnt(16)
    ds_read_b64_tr_b16 v[80:81], v64 offset:6144
    ds_read_b64_tr_b16 v[82:83], v64 offset:6656
    ds_read_b64_tr_b16 v[84:85], v65 offset:6144
    ds_read_b64_tr_b16 v[86:87], v65 offset:6656
    s_waitcnt lgkmcnt(4)
    v_mfma_f32_32x32x16_bf16 a[0:15], v[72:75], v[112:115], a[0:15]
    v_mfma_f32_32x32x16_bf16 a[16:31], v[72:75], v[116:119], a[16:31]
    v_mfma_f32_32x32x16_bf16 a[32:47], v[76:79], v[112:115], a[32:47]
    v_mfma_f32_32x32x16_bf16 a[48:63], v[76:79], v[116:119], a[48:63]
    s_waitcnt vmcnt(12)
    ds_read_b64_tr_b16 v[72:73], v64 offset:8192
    ds_read_b64_tr_b16 v[74:75], v64 offset:8704
    ds_read_b64_tr_b16 v[76:77], v65 offset:8192
    ds_read_b64_tr_b16 v[78:79], v65 offset:8704
    s_waitcnt lgkmcnt(4)
    v_mfma_f32_32x32x16_bf16 a[0:15], v[80:83], v[120:123], a[0:15]
    v_mfma_f32_32x32x16_bf16 a[16:31], v[80:83], v[124:127], a[16:31]
    v_mfma_f32_32x32x16_bf16 a[32:47], v[84:87], v[120:123], a[32:47]
    v_mfma_f32_32x32x16_bf16 a[48:63], v[84:87], v[124:127], a[48:63]
    s_waitcnt vmcnt(8)
    ds_read_b64_tr_b16 v[80:81], v64 offset:10240
    ds_read_b64_tr_b16 v[82:83], v64 offset:10752
    ds_read_b64_tr_b16 v[84:85], v65 offset:10240
    ds_read_b64_tr_b16 v[86:87], v65 offset:10752
    s_waitcnt lgkmcnt(4)
    v_mfma_f32_32x32x16_bf16 a[0:15], v[72:75], v[128:131], a[0:15]
    v_mfma_f32_32x32x16_bf16 a[16:31], v[72:75], v[132:135], a[16:31]
    v_mfma_f32_32x32x16_bf16 a[32:47], v[76:79], v[128:131], a[32:47]
    v_mfma_f32_32x32x16_bf16 a[48:63], v[76:79], v[132:135], a[48:63]
    s_waitcnt vmcnt(4)
    ds_read_b64_tr_b16 v[72:73], v64 offset:12288
    ds_read_b64_tr_b16 v[74:75], v64 offset:12800
    ds_read_b64_tr_b16 v[76:77], v65 offset:12288
    ds_read_b64_tr_b16 v[78:79], v65 offset:12800
    s_waitcnt lgkmcnt(4)
    v_mfma_f32_32x32x16_bf16 a[0:15], v[80:83], v[136:139], a[0:15]
    v_mfma_f32_32x32x16_bf16 a[16:31], v[80:83], v[140:143], a[16:31]
    v_mfma_f32_32x32x16_bf16 a[32:47], v[84:87], v[136:139], a[32:47]
    v_mfma_f32_32x32x16_bf16 a[48:63], v[84:87], v[140:143], a[48:63]
    s_waitcnt vmcnt(0)
    ds_read_b64_tr_b16 v[80:81], v64 offset:14336
    ds_read_b64_tr_b16 v[82:83], v64 offset:14848
    ds_read_b64_tr_b16 v[84:85], v65 offset:14336
    ds_read_b64_tr_b16 v[86:87], v65 offset:14848
    s_waitcnt lgkmcnt(4)
    v_mfma_f32_32x32x16_bf16 a[0:15], v[72:75], v[144:147], a[0:15]
    v_mfma_f32_32x32x16_bf16 a[16:31], v[72:75], v[148:151], a[16:31]
    v_mfma_f32_32x32x16_bf16 a[32:47], v[76:79], v[144:147], a[32:47]
    v_mfma_f32_32x32x16_bf16 a[48:63], v[76:79], v[148:151], a[48:63]
    s_waitcnt lgkmcnt(0)
    v_mfma_f32_32x32x16_bf16 a[0:15], v[80:83], v[152:155], a[0:15]
    v_mfma_f32_32x32x16_bf16 a[16:31], v[80:83], v[156:159], a[16:31]
    v_mfma_f32_32x32x16_bf16 a[32:47], v[84:87], v[152:155], a[32:47]
    v_mfma_f32_32x32x16_bf16 a[48:63], v[84:87], v[156:159], a[48:63]
    s_waitcnt vmcnt(0)
    s_nop 15
    s_nop 3
    s_barrier
    v_accvgpr_read_b32 v16, a0
    v_accvgpr_read_b32 v17, a1
    v_accvgpr_read_b32 v18, a2
    v_accvgpr_read_b32 v19, a3
    v_accvgpr_read_b32 v20, a4
    v_accvgpr_read_b32 v21, a5
    v_accvgpr_read_b32 v22, a6
    v_accvgpr_read_b32 v23, a7
    v_accvgpr_read_b32 v24, a8
    v_accvgpr_read_b32 v25, a9
    v_accvgpr_read_b32 v26, a10
    v_accvgpr_read_b32 v27, a11
    v_accvgpr_read_b32 v28, a12
    v_accvgpr_read_b32 v29, a13
    v_accvgpr_read_b32 v30, a14
    v_accvgpr_read_b32 v31, a15
    v_accvgpr_read_b32 v32, a16
    v_accvgpr_read_b32 v33, a17
    v_accvgpr_read_b32 v34, a18
    v_accvgpr_read_b32 v35, a19
    v_accvgpr_read_b32 v36, a20
    v_accvgpr_read_b32 v37, a21
    v_accvgpr_read_b32 v38, a22
    v_accvgpr_read_b32 v39, a23
    v_accvgpr_read_b32 v40, a24
    v_accvgpr_read_b32 v41, a25
    v_accvgpr_read_b32 v42, a26
    v_accvgpr_read_b32 v43, a27
    v_accvgpr_read_b32 v44, a28
    v_accvgpr_read_b32 v45, a29
    v_accvgpr_read_b32 v46, a30
    v_accvgpr_read_b32 v47, a31
    v_accvgpr_read_b32 v48, a32
    v_accvgpr_read_b32 v49, a33
    v_accvgpr_read_b32 v50, a34
    v_accvgpr_read_b32 v51, a35
    v_accvgpr_read_b32 v52, a36
    v_accvgpr_read_b32 v53, a37
    v_accvgpr_read_b32 v54, a38
    v_accvgpr_read_b32 v55, a39
    v_accvgpr_read_b32 v56, a40
    v_accvgpr_read_b32 v57, a41
    v_accvgpr_read_b32 v58, a42
    v_accvgpr_read_b32 v59, a43
    v_accvgpr_read_b32 v60, a44
    v_accvgpr_read_b32 v61, a45
    v_accvgpr_read_b32 v62, a46
    v_accvgpr_read_b32 v63, a47
    v_accvgpr_read_b32 v64, a48
    v_accvgpr_read_b32 v65, a49
    v_accvgpr_read_b32 v66, a50
    v_accvgpr_read_b32 v67, a51
    v_accvgpr_read_b32 v68, a52
    v_accvgpr_read_b32 v69, a53
    v_accvgpr_read_b32 v70, a54
    v_accvgpr_read_b32 v71, a55
    v_accvgpr_read_b32 v72, a56
    v_accvgpr_read_b32 v73, a57
    v_accvgpr_read_b32 v74, a58
    v_accvgpr_read_b32 v75, a59
    v_accvgpr_read_b32 v76, a60
    v_accvgpr_read_b32 v77, a61
    v_accvgpr_read_b32 v78, a62
    v_accvgpr_read_b32 v79, a63
    s_lshl_b32 s34, s3, 14
    v_add_u32 v4, s34, v3
    s_cmp_eq_u32 s3, 0
    s_cbranch_scc1 k5_kernel_skipw0
    ds_write_b128 v4, v[16:19] offset:0
    ds_write_b128 v4, v[20:23] offset:1024
    ds_write_b128 v4, v[24:27] offset:2048
    ds_write_b128 v4, v[28:31] offset:3072
k5_kernel_skipw0:
    s_cmp_eq_u32 s3, 1
    s_cbranch_scc1 k5_kernel_skipw1
    ds_write_b128 v4, v[32:35] offset:4096
    ds_write_b128 v4, v[36:39] offset:5120
    ds_write_b128 v4, v[40:43] offset:6144
    ds_write_b128 v4, v[44:47] offset:7168
k5_kernel_skipw1:
    s_cmp_eq_u32 s3, 2
    s_cbranch_scc1 k5_kernel_skipw2
    ds_write_b128 v4, v[48:51] offset:8192
    ds_write_b128 v4, v[52:55] offset:9216
    ds_write_b128 v4, v[56:59] offset:10240
    ds_write_b128 v4, v[60:63] offset:11264
k5_kernel_skipw2:
    s_cmp_eq_u32 s3, 3
    s_cbranch_scc1 k5_kernel_skipw3
    ds_write_b128 v4, v[64:67] offset:12288
    ds_write_b128 v4, v[68:71] offset:13312
    ds_write_b128 v4, v[72:75] offset:14336
    ds_write_b128 v4, v[76:79] offset:15360
k5_kernel_skipw3:
    s_waitcnt lgkmcnt(0)
    s_barrier
    s_cmp_lg_u32 s3, 0
    s_cbranch_scc1 k5_kernel_skipm0
    v_mov_b32 v80, v16
    v_mov_b32 v81, v17
    v_mov_b32 v82, v18
    v_mov_b32 v83, v19
    v_mov_b32 v84, v20
    v_mov_b32 v85, v21
    v_mov_b32 v86, v22
    v_mov_b32 v87, v23
    v_mov_b32 v88, v24
    v_mov_b32 v89, v25
    v_mov_b32 v90, v26
    v_mov_b32 v91, v27
    v_mov_b32 v92, v28
    v_mov_b32 v93, v29
    v_mov_b32 v94, v30
    v_mov_b32 v95, v31
k5_kernel_skipm0:
    s_cmp_lg_u32 s3, 1
    s_cbranch_scc1 k5_kernel_skipm1
    v_mov_b32 v80, v32
    v_mov_b32 v81, v33
    v_mov_b32 v82, v34
    v_mov_b32 v83, v35
    v_mov_b32 v84, v36
    v_mov_b32 v85, v37
    v_mov_b32 v86, v38
    v_mov_b32 v87, v39
    v_mov_b32 v88, v40
    v_mov_b32 v89, v41
    v_mov_b32 v90, v42
    v_mov_b32 v91, v43
    v_mov_b32 v92, v44
    v_mov_b32 v93, v45
    v_mov_b32 v94, v46
    v_mov_b32 v95, v47
k5_kernel_skipm1:
    s_cmp_lg_u32 s3, 2
    s_cbranch_scc1 k5_kernel_skipm2
    v_mov_b32 v80, v48
    v_mov_b32 v81, v49
    v_mov_b32 v82, v50
    v_mov_b32 v83, v51
    v_mov_b32 v84, v52
    v_mov_b32 v85, v53
    v_mov_b32 v86, v54
    v_mov_b32 v87, v55
    v_mov_b32 v88, v56
    v_mov_b32 v89, v57
    v_mov_b32 v90, v58
    v_mov_b32 v91, v59
    v_mov_b32 v92, v60
    v_mov_b32 v93, v61
    v_mov_b32 v94, v62
    v_mov_b32 v95, v63
k5_kernel_skipm2:
    s_cmp_lg_u32 s3, 3
    s_cbranch_scc1 k5_kernel_skipm3
    v_mov_b32 v80, v64
    v_mov_b32 v81, v65
    v_mov_b32 v82, v66
    v_mov_b32 v83, v67
    v_mov_b32 v84, v68
    v_mov_b32 v85, v69
    v_mov_b32 v86, v70
    v_mov_b32 v87, v71
    v_mov_b32 v88, v72
    v_mov_b32 v89, v73
    v_mov_b32 v90, v74
    v_mov_b32 v91, v75
    v_mov_b32 v92, v76
    v_mov_b32 v93, v77
    v_mov_b32 v94, v78
    v_mov_b32 v95, v79
k5_kernel_skipm3:
    s_lshl_b32 s34, s3, 12
    v_add_u32 v4, s34, v3
    ds_read_b128 v[96:99], v4 offset:0
    ds_read_b128 v[100:103], v4 offset:1024
    ds_read_b128 v[104:107], v4 offset:2048
    ds_read_b128 v[108:111], v4 offset:3072
    ds_read_b128 v[112:115], v4 offset:16384
    ds_read_b128 v[116:119], v4 offset:17408
    ds_read_b128 v[120:123], v4 offset:18432
    ds_read_b128 v[124:127], v4 offset:19456
    ds_read_b128 v[128:131], v4 offset:32768
    ds_read_b128 v[132:135], v4 offset:33792
    ds_read_b128 v[136:139], v4 offset:34816
    ds_read_b128 v[140:143], v4 offset:35840
    ds_read_b128 v[144:147], v4 offset:49152
    ds_read_b128 v[148:151], v4 offset:50176
    ds_read_b128 v[152:155], v4 offset:51200
    ds_read_b128 v[156:159], v4 offset:52224
    s_waitcnt lgkmcnt(0)
    s_cmp_eq_u32 s3, 0
    s_cbranch_scc1 k5_kernel_skipa0
    v_add_f32 v80, v80, v96
    v_add_f32 v81, v81, v97
    v_add_f32 v82, v82, v98
    v_add_f32 v83, v83, v99
    v_add_f32 v84, v84, v100
    v_add_f32 v85, v85, v101
    v_add_f32 v86, v86, v102
    v_add_f32 v87, v87, v103
    v_add_f32 v88, v88, v104
    v_add_f32 v89, v89, v105
    v_add_f32 v90, v90, v106
    v_add_f32 v91, v91, v107
    v_add_f32 v92, v92, v108
    v_add_f32 v93, v93, v109
    v_add_f32 v94, v94, v110
    v_add_f32 v95, v95, v111
k5_kernel_skipa0:
    s_cmp_eq_u32 s3, 1
    s_cbranch_scc1 k5_kernel_skipa1
    v_add_f32 v80, v80, v112
    v_add_f32 v81, v81, v113
    v_add_f32 v82, v82, v114
    v_add_f32 v83, v83, v115
    v_add_f32 v84, v84, v116
    v_add_f32 v85, v85, v117
    v_add_f32 v86, v86, v118
    v_add_f32 v87, v87, v119
    v_add_f32 v88, v88, v120
    v_add_f32 v89, v89, v121
    v_add_f32 v90, v90, v122
    v_add_f32 v91, v91, v123
    v_add_f32 v92, v92, v124
    v_add_f32 v93, v93, v125
    v_add_f32 v94, v94, v126
    v_add_f32 v95, v95, v127
k5_kernel_skipa1:
    s_cmp_eq_u32 s3, 2
    s_cbranch_scc1 k5_kernel_skipa2
    v_add_f32 v80, v80, v128
    v_add_f32 v81, v81, v129
    v_add_f32 v82, v82, v130
    v_add_f32 v83, v83, v131
    v_add_f32 v84, v84, v132
    v_add_f32 v85, v85, v133
    v_add_f32 v86, v86, v134
    v_add_f32 v87, v87, v135
    v_add_f32 v88, v88, v136
    v_add_f32 v89, v89, v137
    v_add_f32 v90, v90, v138
    v_add_f32 v91, v91, v139
    v_add_f32 v92, v92, v140
    v_add_f32 v93, v93, v141
    v_add_f32 v94, v94, v142
    v_add_f32 v95, v95, v143
k5_kernel_skipa2:
    s_cmp_eq_u32 s3, 3
    s_cbranch_scc1 k5_kernel_skipa3
    v_add_f32 v80, v80, v144
    v_add_f32 v81, v81, v145
    v_add_f32 v82, v82, v146
    v_add_f32 v83, v83, v147
    v_add_f32 v84, v84, v148
    v_add_f32 v85, v85, v149
    v_add_f32 v86, v86, v150
    v_add_f32 v87, v87, v151
    v_add_f32 v88, v88, v152
    v_add_f32 v89, v89, v153
    v_add_f32 v90, v90, v154
    v_add_f32 v91, v91, v155
    v_add_f32 v92, v92, v156
    v_add_f32 v93, v93, v157
    v_add_f32 v94, v94, v158
    v_add_f32 v95, v95, v159
k5_kernel_skipa3:
    v_cvt_pk_bf16_f32 v4, v80, v81
    v_lshlrev_b32 v80, 16, v4
    v_and_b32 v81, 0xffff0000, v4
    v_cvt_pk_bf16_f32 v4, v82, v83
    v_lshlrev_b32 v82, 16, v4
    v_and_b32 v83, 0xffff0000, v4
    v_cvt_pk_bf16_f32 v4, v84, v85
    v_lshlrev_b32 v84, 16, v4
    v_and_b32 v85, 0xffff0000, v4
    v_cvt_pk_bf16_f32 v4, v86, v87
    v_lshlrev_b32 v86, 16, v4
    v_and_b32 v87, 0xffff0000, v4
    v_cvt_pk_bf16_f32 v4, v88, v89
    v_lshlrev_b32 v88, 16, v4
    v_and_b32 v89, 0xffff0000, v4
    v_cvt_pk_bf16_f32 v4, v90, v91
    v_lshlrev_b32 v90, 16, v4
    v_and_b32 v91, 0xffff0000, v4
    v_cvt_pk_bf16_f32 v4, v92, v93
    v_lshlrev_b32 v92, 16, v4
    v_and_b32 v93, 0xffff0000, v4
    v_cvt_pk_bf16_f32 v4, v94, v95
    v_lshlrev_b32 v94, 16, v4
    v_and_b32 v95, 0xffff0000, v4
    v_mul_f32 v80, v80, v240
    v_mul_f32 v81, v81, v241
    v_mul_f32 v82, v82, v242
    v_mul_f32 v83, v83, v243
    v_mul_f32 v84, v84, v244
    v_mul_f32 v85, v85, v245
    v_mul_f32 v86, v86, v246
    v_mul_f32 v87, v87, v247
    v_mul_f32 v88, v88, v248
    v_mul_f32 v89, v89, v249
    v_mul_f32 v90, v90, v250
    v_mul_f32 v91, v91, v251
    v_mul_f32 v92, v92, v252
    v_mul_f32 v93, v93, v253
    v_mul_f32 v94, v94, v254
    v_mul_f32 v95, v95, v255
    v_cvt_pk_bf16_f32 v4, v80, v81
    v_lshlrev_b32 v80, 16, v4
    v_and_b32 v81, 0xffff0000, v4
    v_cvt_pk_bf16_f32 v4, v82, v83
    v_lshlrev_b32 v82, 16, v4
    v_and_b32 v83, 0xffff0000, v4
    v_cvt_pk_bf16_f32 v4, v84, v85
    v_lshlrev_b32 v84, 16, v4
    v_and_b32 v85, 0xffff0000, v4
    v_cvt_pk_bf16_f32 v4, v86, v87
    v_lshlrev_b32 v86, 16, v4
    v_and_b32 v87, 0xffff0000, v4
    v_cvt_pk_bf16_f32 v4, v88, v89
    v_lshlrev_b32 v88, 16, v4
    v_and_b32 v89, 0xffff0000, v4
    v_cvt_pk_bf16_f32 v4, v90, v91
    v_lshlrev_b32 v90, 16, v4
    v_and_b32 v91, 0xffff0000, v4
    v_cvt_pk_bf16_f32 v4, v92, v93
    v_lshlrev_b32 v92, 16, v4
    v_and_b32 v93, 0xffff0000, v4
    v_cvt_pk_bf16_f32 v4, v94, v95
    v_lshlrev_b32 v94, 16, v4
    v_and_b32 v95, 0xffff0000, v4
    v_lshlrev_b32 v96, 16, v8
    v_and_b32 v97, 0xffff0000, v8
    v_lshlrev_b32 v98, 16, v9
    v_and_b32 v99, 0xffff0000, v9
    v_lshlrev_b32 v100, 16, v10
    v_and_b32 v101, 0xffff0000, v10
    v_lshlrev_b32 v102, 16, v11
    v_and_b32 v103, 0xffff0000, v11
    v_lshlrev_b32 v104, 16, v12
    v_and_b32 v105, 0xffff0000, v12
    v_lshlrev_b32 v106, 16, v13
    v_and_b32 v107, 0xffff0000, v13
    v_lshlrev_b32 v108, 16, v14
    v_and_b32 v109, 0xffff0000, v14
    v_lshlrev_b32 v110, 16, v15
    v_and_b32 v111, 0xffff0000, v15
    v_add_f32 v80, v80, v96
    v_add_f32 v81, v81, v97
    v_add_f32 v82, v82, v98
    v_add_f32 v83, v83, v99
    v_add_f32 v84, v84, v100
    v_add_f32 v85, v85, v101
    v_add_f32 v86, v86, v102
    v_add_f32 v87, v87, v103
    v_add_f32 v88, v88, v104
    v_add_f32 v89, v89, v105
    v_add_f32 v90, v90, v106
    v_add_f32 v91, v91, v107
    v_add_f32 v92, v92, v108
    v_add_f32 v93, v93, v109
    v_add_f32 v94, v94, v110
    v_add_f32 v95, v95, v111
    v_cvt_pk_bf16_f32 v112, v80, v81
    v_cvt_pk_bf16_f32 v113, v82, v83
    v_cvt_pk_bf16_f32 v114, v84, v85
    v_cvt_pk_bf16_f32 v115, v86, v87
    v_cvt_pk_bf16_f32 v116, v88, v89
    v_cvt_pk_bf16_f32 v117, v90, v91
    v_cvt_pk_bf16_f32 v118, v92, v93
    v_cvt_pk_bf16_f32 v119, v94, v95
    s_nop 1
    v_permlane32_swap_b32 v112, v114
    v_permlane32_swap_b32 v113, v115
    v_permlane32_swap_b32 v116, v118
    v_permlane32_swap_b32 v117, v119
    v_and_b32 v4, 31, v2
    v_lshlrev_b32 v4, 10, v4
    v_lshl_add_u32 v4, v5, 4, v4
    buffer_store_dwordx4 v[112:115], v4, s[4:7], s24 offen
    buffer_store_dwordx4 v[116:119], v4, s[4:7], s24 offen offset:32
k5_kernel_end:
    s_endpgm
.section .rodata,"a"
.p2align 6
.amdhsa_kernel k0_kernel
  .amdhsa_next_free_vgpr 112
  .amdhsa_next_free_sgpr 102
  .amdhsa_accum_offset 112
  .amdhsa_group_segment_fixed_size 0
  .amdhsa_kernarg_size 112
  .amdhsa_user_sgpr_count 2
  .amdhsa_user_sgpr_kernarg_segment_ptr 1
  .amdhsa_system_sgpr_workgroup_id_x 1
.end_amdhsa_kernel
.p2align 6
.amdhsa_kernel k1_kernel
  .amdhsa_next_free_vgpr 256
  .amdhsa_next_free_sgpr 102
  .amdhsa_accum_offset 256
  .amdhsa_group_segment_fixed_size 0
  .amdhsa_kernarg_size 112
  .amdhsa_user_sgpr_count 2
  .amdhsa_user_sgpr_kernarg_segment_ptr 1
  .amdhsa_system_sgpr_workgroup_id_x 1
.end_amdhsa_kernel
.p2align 6
.amdhsa_kernel k2_kernel
  .amdhsa_next_free_vgpr 256
  .amdhsa_next_free_sgpr 102
  .amdhsa_accum_offset 256
  .amdhsa_group_segment_fixed_size 0
  .amdhsa_kernarg_size 112
  .amdhsa_user_sgpr_count 2
  .amdhsa_user_sgpr_kernarg_segment_ptr 1
  .amdhsa_system_sgpr_workgroup_id_x 1
.end_amdhsa_kernel
.p2align 6
.amdhsa_kernel k4_kernel
  .amdhsa_next_free_vgpr 368
  .amdhsa_next_free_sgpr 102
  .amdhsa_accum_offset 256
  .amdhsa_group_segment_fixed_size 0
  .amdhsa_kernarg_size 112
  .amdhsa_user_sgpr_count 2
  .amdhsa_user_sgpr_kernarg_segment_ptr 1
  .amdhsa_system_sgpr_workgroup_id_x 1
.end_amdhsa_kernel
.p2align 6
.amdhsa_kernel k5_kernel
  .amdhsa_next_free_vgpr 320
  .amdhsa_next_free_sgpr 102
  .amdhsa_accum_offset 256
  .amdhsa_group_segment_fixed_size 0
  .amdhsa_kernarg_size 112
  .amdhsa_user_sgpr_count 2
  .amdhsa_user_sgpr_kernarg_segment_ptr 1
  .amdhsa_system_sgpr_workgroup_id_x 1
.end_amdhsa_kernel
```
